```python
import torch

def _softmax(x, axis=-1):
    return torch.softmax(x, dim=axis)
def _gelu(x):
    return torch.nn.functional.gelu(x, approximate="tanh")
def _silu(x):
    return torch.nn.functional.silu(x)
def _sigmoid(x):
    return torch.sigmoid(x)
def _layernorm(x, axis=-1, eps=1e-5):
    m = x.mean(dim=axis, keepdim=True)
    v = x.var(dim=axis, keepdim=True, unbiased=False)
    return (x - m) / torch.sqrt(v + eps)
def _scatter_add(tgt, idx, src, axis=0):
    return tgt.clone().index_add_(axis, idx, src)
def _segment_sum(src, seg, n):
    out = torch.zeros((n,) + src.shape[1:], dtype=src.dtype)
    return out.index_add_(0, seg, src)
def _pad(x, pw):
    flat = tuple(v for pair in reversed(pw) for v in pair)
    return torch.nn.functional.pad(x, flat)

kernel_name = 'standalone__swiglu_ffn__prompt'

def setup_inputs():

    _w = (lambda a: (lambda t: t.to(torch.bfloat16) if t.is_floating_point() else t)(torch.as_tensor(a)))
    B, S, D, F = 1, 2048, 640, 1728
    return {
        "x": _w((lambda *s: torch.randn(*s, dtype=torch.bfloat16) * 0.05)(B, S, D)),
        "w_gate": _w((lambda *s: torch.randn(*s, dtype=torch.bfloat16) * 0.05)(D, F)),
        "w_up": _w((lambda *s: torch.randn(*s, dtype=torch.bfloat16) * 0.05)(D, F)),
        "w_down": _w((lambda *s: torch.randn(*s, dtype=torch.bfloat16) * 0.05)(F, D)),
    }

def reference(x, w_gate, w_up, w_down):
    g = _silu(x @ w_gate)
    u = x @ w_up
    return (g * u) @ w_down
```

```asm
; @launch grid=(256,1,1) block=(256,1,1) lds=147456
.amdgcn_target "amdgcn-amd-amdhsa--gfx950"
.text
.globl standalone__swiglu_ffn__prompt_kernel
.p2align 8
.type standalone__swiglu_ffn__prompt_kernel,@function
standalone__swiglu_ffn__prompt_kernel:
    s_cmp_ge_u32 s2, 256
    s_cbranch_scc1 standalone__swiglu_ffn__prompt_kernel_end
    s_load_dwordx8 s[72:79], s[0:1], 0
    s_load_dwordx4 s[80:83], s[0:1], 32
    s_load_dwordx2 s[84:85], s[0:1], 48
    s_getpc_b64 s[4:5]
standalone__swiglu_ffn__prompt_kernel_pc0:
    s_sub_u32 s4, s4, standalone__swiglu_ffn__prompt_kernel_pc0-standalone__swiglu_ffn__prompt_kernel
    s_subb_u32 s5, s5, 0
    v_lshlrev_b32 v4, 4, v0
    v_add_u32 v5, 0, v4
    v_min_u32 v5, standalone__swiglu_ffn__prompt_kernel_codeend-standalone__swiglu_ffn__prompt_kernel-16, v5
    v_mov_b32 v3, s5
    v_add_co_u32 v2, vcc, s4, v5
    s_nop 1
    v_addc_co_u32 v3, vcc, 0, v3, vcc
    global_load_dwordx4 a[200:203], v[2:3], off
    v_add_u32 v5, 4096, v4
    v_min_u32 v5, standalone__swiglu_ffn__prompt_kernel_codeend-standalone__swiglu_ffn__prompt_kernel-16, v5
    v_mov_b32 v3, s5
    v_add_co_u32 v2, vcc, s4, v5
    s_nop 1
    v_addc_co_u32 v3, vcc, 0, v3, vcc
    global_load_dwordx4 a[204:207], v[2:3], off
    v_and_b32 v4, 7, v0
    v_lshlrev_b32 v4, 12, v4
    v_add_u32 v4, standalone__swiglu_ffn__prompt_kernel_stub1-standalone__swiglu_ffn__prompt_kernel, v4
    v_min_u32 v4, standalone__swiglu_ffn__prompt_kernel_codeend-standalone__swiglu_ffn__prompt_kernel-4, v4
    v_mov_b32 v3, s5
    v_add_co_u32 v2, vcc, s4, v4
    s_nop 1
    v_addc_co_u32 v3, vcc, 0, v3, vcc
    global_load_dword a220, v[2:3], off
    v_lshrrev_b32 v2, 6, v0
    v_and_b32 v1, 63, v0
    s_and_b32 s36, s2, 7
    v_readfirstlane_b32 s3, v2
    s_lshr_b32 s37, s2, 3
    v_lshlrev_b32 v22, 4, v1
    v_add_u32 v125, 0x1000, v22
    v_add_u32 v126, 0x2000, v22
    v_add_u32 v127, 0x3000, v22
    s_waitcnt lgkmcnt(0)
    s_mov_b32 s8, s72
    s_mov_b32 s9, s73
    s_mov_b32 s10, 2621440
    s_mov_b32 s11, 0x20000
    s_mov_b32 s12, s74
    s_mov_b32 s13, s75
    s_mov_b32 s14, 2211840
    s_mov_b32 s15, 0x20000
    s_sub_u32 s16, s76, 2048
    s_subb_u32 s17, s77, 0
    s_mov_b32 s18, 2213888
    s_mov_b32 s19, 0x20000
    s_mov_b32 s24, s78
    s_mov_b32 s25, s79
    s_mov_b32 s26, 2211840
    s_mov_b32 s27, 0x20000
    s_mov_b32 s28, s80
    s_mov_b32 s29, s81
    s_mov_b32 s30, 2621440
    s_mov_b32 s31, 0x20000
    s_mov_b32 s32, s82
    s_mov_b32 s33, s83
    s_mov_b32 s34, 256
    s_mov_b32 s35, 0x20000
    s_mov_b32 s20, s84
    s_mov_b32 s21, s85
    s_mov_b32 s22, 268435456
    s_mov_b32 s23, 0x20000
    v_mov_b32 v2, 0
    s_mov_b32 s4, 12910592
    buffer_load_dword v61, v2, s[20:23], s4 offen sc1
    s_cmp_ge_u32 s37, 27
    s_cbranch_scc1 standalone__swiglu_ffn__prompt_kernel_p0
    s_mul_i32 s50, s36, 27
    s_add_u32 s50, s50, s37
    s_cmp_eq_u32 s3, 1
    s_cselect_b32 s68, s12, s8
    s_cselect_b32 s69, s13, s9
    s_cselect_b32 s70, s14, s10
    s_cmp_eq_u32 s3, 2
    s_cselect_b32 s68, s16, s68
    s_cselect_b32 s69, s17, s69
    s_cselect_b32 s70, s18, s70
    s_mov_b32 s71, 0x20000
    s_cselect_b32 s92, 2048, 0
    s_cmp_eq_u32 s3, 0
    s_cbranch_scc1 standalone__swiglu_ffn__prompt_kernel_cs_x
    s_cmp_eq_u32 s3, 3
    s_cbranch_scc1 standalone__swiglu_ffn__prompt_kernel_cs_x
    s_mov_b32 s93, 221184
    s_mov_b32 s51, 8
    s_lshl_b32 s52, s50, 3
    v_add_u32 v24, s52, v1
    v_lshlrev_b32 v24, 7, v24
    s_branch standalone__swiglu_ffn__prompt_kernel_cs_j
standalone__swiglu_ffn__prompt_kernel_cs_x:
    s_mov_b32 s93, 128
    s_mov_b32 s51, 5
    s_mul_i32 s52, s50, 10
    s_cmp_eq_u32 s3, 0
    s_cselect_b32 s53, 0, 5
    s_add_u32 s52, s52, s53
    v_add_u32 v24, s52, v1
    v_min_u32 v24, 2047, v24
    v_mul_u32_u24 v24, 1280, v24
standalone__swiglu_ffn__prompt_kernel_cs_j:
    v_mov_b32 v25, 0x7ffffff0
    v_cmp_gt_u32 vcc, s51, v1
    s_nop 1
    v_cndmask_b32 v63, v25, v24, vcc
    buffer_load_dword v32, v63, s[68:71], s92 offen
    s_add_u32 s92, s92, s93
    buffer_load_dword v33, v63, s[68:71], s92 offen
    s_add_u32 s92, s92, s93
    buffer_load_dword v34, v63, s[68:71], s92 offen
    s_add_u32 s92, s92, s93
    buffer_load_dword v35, v63, s[68:71], s92 offen
    s_add_u32 s92, s92, s93
    s_lshr_b32 s50, s36, 1
    s_mul_i32 s50, s50, 27
    s_add_u32 s50, s50, s37
    s_lshr_b32 s39, s50, 2
    s_and_b32 s50, s50, 3
    s_and_b32 s51, s36, 1
    s_lshl_b32 s51, s51, 2
    s_add_u32 s38, s50, s51
    s_lshl_b32 s50, s38, 8
    s_lshl_b32 s51, s3, 6
    s_add_u32 s50, s50, s51
    s_mul_i32 s40, s50, 1280
    s_add_u32 s41, s40, 40960
    s_mul_i32 s42, s3, 55296
    s_lshl_b32 s50, s39, 7
    s_add_u32 s42, s42, s50
    s_lshl_b32 s43, s3, 13
    s_lshl_b32 s44, s3, 12
    s_add_u32 s44, s44, 32768
    v_lshrrev_b32 v2, 3, v1
    v_and_b32 v3, 7, v1
    v_lshrrev_b32 v24, 4, v1
    v_xor_b32 v25, v3, v24
    v_mul_u32_u24 v26, 1280, v2
    v_lshl_add_u32 v4, v25, 4, v26
    v_xor_b32 v25, 64, v4
    v_add_u32 v5, 9216, v25
    v_add_u32 v6, 18432, v4
    v_add_u32 v7, 27648, v25
    v_lshrrev_b32 v25, 1, v2
    v_and_b32 v25, 1, v25
    v_lshlrev_b32 v26, 1, v25
    v_xor_b32 v26, v26, v3
    v_lshlrev_b32 v26, 4, v26
    v_mul_u32_u24 v27, 3456, v2
    v_add_u32 v8, v27, v26
    v_or_b32 v25, 2, v25
    v_lshlrev_b32 v26, 1, v25
    v_xor_b32 v26, v26, v3
    v_lshlrev_b32 v26, 4, v26
    v_add_u32 v27, 26624, v27
    v_add_u32 v9, v27, v26
    s_add_u32 m0, s43, 0
    s_nop 0
    buffer_load_dwordx4 v4, s[8:11], s40 offen lds
    buffer_load_dwordx4 v5, s[8:11], s40 offen offset:1024 lds
    buffer_load_dwordx4 v6, s[8:11], s40 offen offset:2048 lds
    buffer_load_dwordx4 v7, s[8:11], s40 offen offset:3072 lds
    s_add_u32 s40, s40, 128
    s_add_u32 m0, s43, 4096
    s_nop 0
    buffer_load_dwordx4 v4, s[8:11], s41 offen lds
    buffer_load_dwordx4 v5, s[8:11], s41 offen offset:1024 lds
    buffer_load_dwordx4 v6, s[8:11], s41 offen offset:2048 lds
    buffer_load_dwordx4 v7, s[8:11], s41 offen offset:3072 lds
    s_add_u32 s41, s41, 128
    s_add_u32 m0, s44, 0
    s_nop 0
    buffer_load_dwordx4 v8, s[12:15], s42 offen lds
    buffer_load_dwordx4 v9, s[12:15], s42 offen offset:1024 lds
    buffer_load_dwordx4 v8, s[16:19], s42 offen offset:2048 lds
    buffer_load_dwordx4 v9, s[16:19], s42 offen offset:3072 lds
    s_add_u32 s42, s42, 221184
    s_mov_b32 s46, 3216550459
    s_mov_b32 s47, 3216550459
    s_mov_b32 s48, 1.0
    s_mov_b32 s49, 1.0
    s_lshr_b32 s50, s3, 1
    s_lshl_b32 s50, s50, 3
    s_lshl_b32 s51, s38, 4
    s_add_u32 s50, s50, s51
    s_mul_i32 s50, s50, 54
    s_and_b32 s51, s3, 1
    s_add_u32 s50, s50, s51
    s_lshl_b32 s51, s39, 1
    s_add_u32 s50, s50, s51
    s_lshl_b32 s54, s50, 10
    s_add_u32 s54, s54, 0
    s_lshl_b32 s50, s38, 1
    s_lshr_b32 s51, s3, 1
    s_add_u32 s50, s50, s51
    s_lshl_b32 s50, s50, 6
    s_lshl_b32 s51, s39, 1
    s_add_u32 s50, s50, s51
    s_and_b32 s51, s3, 1
    s_add_u32 s50, s50, s51
    s_lshl_b32 s55, s50, 8
    s_add_u32 s55, s55, 12582912
    v_and_b32 v2, 15, v1
    v_lshrrev_b32 v3, 4, v1
    s_lshr_b32 s50, s3, 1
    s_lshl_b32 s50, s50, 14
    v_lshlrev_b32 v25, 7, v2
    v_add_u32 v25, s50, v25
    v_lshrrev_b32 v26, 1, v2
    v_add_u32 v27, 0, v3
    v_xor_b32 v27, v27, v26
    v_lshl_add_u32 v27, v27, 4, v25
    v_add_u32 v10, 0, v27
    v_add_u32 v12, 49152, v27
    v_add_u32 v14, 98304, v27
    v_add_u32 v27, 4, v3
    v_xor_b32 v27, v27, v26
    v_lshl_add_u32 v27, v27, 4, v25
    v_add_u32 v11, 0, v27
    v_add_u32 v13, 49152, v27
    v_add_u32 v15, 98304, v27
    v_lshrrev_b32 v25, 2, v2
    v_and_b32 v26, 3, v2
    v_and_b32 v27, 1, v3
    v_lshrrev_b32 v28, 1, v25
    v_lshl_add_u32 v28, v27, 1, v28
    v_lshl_add_u32 v25, v27, 3, v25
    v_lshlrev_b32 v25, 7, v25
    v_lshrrev_b32 v27, 1, v3
    v_lshl_add_u32 v25, v27, 12, v25
    v_lshl_add_u32 v25, v26, 3, v25
    v_add_u32 v25, 32768, v25
    s_and_b32 s50, s3, 1
    s_lshl_b32 s50, s50, 1
    s_add_u32 s51, s50, 0
    v_xor_b32 v27, s51, v28
    v_lshl_add_u32 v27, v27, 5, v25
    v_add_u32 v16, 0, v27
    v_add_u32 v18, 49152, v27
    v_add_u32 v20, 98304, v27
    s_add_u32 s51, s50, 1
    v_xor_b32 v27, s51, v28
    v_lshl_add_u32 v27, v27, 5, v25
    v_add_u32 v17, 0, v27
    v_add_u32 v19, 49152, v27
    v_add_u32 v21, 98304, v27
    s_add_u32 m0, s43, 49152
    s_nop 0
    buffer_load_dwordx4 v4, s[8:11], s40 offen lds
    buffer_load_dwordx4 v5, s[8:11], s40 offen offset:1024 lds
    buffer_load_dwordx4 v6, s[8:11], s40 offen offset:2048 lds
    buffer_load_dwordx4 v7, s[8:11], s40 offen offset:3072 lds
    s_add_u32 s40, s40, 128
    s_add_u32 m0, s43, 53248
    s_nop 0
    buffer_load_dwordx4 v4, s[8:11], s41 offen lds
    buffer_load_dwordx4 v5, s[8:11], s41 offen offset:1024 lds
    buffer_load_dwordx4 v6, s[8:11], s41 offen offset:2048 lds
    buffer_load_dwordx4 v7, s[8:11], s41 offen offset:3072 lds
    s_add_u32 s41, s41, 128
    s_add_u32 m0, s44, 49152
    s_nop 0
    buffer_load_dwordx4 v8, s[12:15], s42 offen lds
    buffer_load_dwordx4 v9, s[12:15], s42 offen offset:1024 lds
    buffer_load_dwordx4 v8, s[16:19], s42 offen offset:2048 lds
    buffer_load_dwordx4 v9, s[16:19], s42 offen offset:3072 lds
    s_add_u32 s42, s42, 221184
    s_lshr_b32 s50, s37, 2
    s_lshr_b32 s51, s36, 1
    s_lshl_b32 s51, s51, 3
    s_add_u32 s61, s50, s51
    s_and_b32 s62, s37, 3
    s_and_b32 s51, s36, 1
    s_lshl_b32 s51, s51, 2
    s_add_u32 s62, s62, s51
    s_mul_i32 s52, s3, 14
    s_sub_u32 s53, s3, 1
    s_cmp_ge_u32 s3, 2
    s_cselect_b32 s53, s53, 0
    s_sub_u32 s52, s52, s53
    s_mul_i32 s60, s52, 40
    s_mul_i32 s53, s62, 5
    s_add_u32 s60, s60, s53
    s_lshl_b32 s60, s60, 10
    s_add_u32 s66, s60, 8388608
    s_add_u32 s60, s66, 40960
    s_lshr_b32 s53, s61, 1
    s_lshl_b32 s53, s53, 6
    s_add_u32 s53, s53, s52
    s_lshl_b32 s64, s53, 8
    s_add_u32 s64, s64, 12582912
    s_lshr_b32 s50, s61, 1
    s_lshl_b32 s50, s50, 3
    s_and_b32 s51, s61, 1
    s_lshl_b32 s51, s51, 1
    s_add_u32 s50, s50, s51
    s_cmp_eq_u32 s3, 2
    s_cselect_b32 s53, 1, 0
    s_add_u32 s53, s53, s50
    s_mul_i32 s53, s53, 54
    s_add_u32 s53, s53, s52
    s_lshl_b32 s53, s53, 10
    s_add_u32 s56, s53, 0
    s_cmp_eq_u32 s3, 2
    s_cselect_b32 s53, 0, 1
    s_add_u32 s53, s53, s50
    s_mul_i32 s53, s53, 54
    s_add_u32 s53, s53, s52
    s_lshl_b32 s53, s53, 10
    s_add_u32 s57, s53, 0
    s_cmp_eq_u32 s3, 0
    s_cselect_b32 s53, 5, 4
    s_add_u32 s53, s53, s50
    s_mul_i32 s53, s53, 54
    s_add_u32 s53, s53, s52
    s_lshl_b32 s53, s53, 10
    s_add_u32 s58, s53, 0
    s_cmp_eq_u32 s3, 0
    s_cselect_b32 s53, 4, 5
    s_add_u32 s53, s53, s50
    s_mul_i32 s53, s53, 54
    s_add_u32 s53, s53, s52
    s_lshl_b32 s53, s53, 10
    s_add_u32 s59, s53, 0
    s_and_b32 s51, s3, 1
    s_add_u32 s50, s50, s51
    s_cmp_lt_u32 s3, 2
    s_cselect_b32 s51, 4, 0
    s_add_u32 s50, s50, s51
    s_mul_i32 s50, s50, 20480
    s_mul_i32 s51, s62, 160
    s_add_u32 s67, s50, s51
    s_cmp_lg_u32 s3, 0
    s_cbranch_scc1 standalone__swiglu_ffn__prompt_kernel_pw0
    s_call_b64 s[4:5], standalone__swiglu_ffn__prompt_kernel_stub2
standalone__swiglu_ffn__prompt_kernel_pw0:
    s_cmp_lg_u32 s3, 1
    s_cbranch_scc1 standalone__swiglu_ffn__prompt_kernel_pw1
    s_call_b64 s[4:5], standalone__swiglu_ffn__prompt_kernel_stub3
standalone__swiglu_ffn__prompt_kernel_pw1:
    s_cmp_lg_u32 s3, 2
    s_cbranch_scc1 standalone__swiglu_ffn__prompt_kernel_pw2
    s_call_b64 s[4:5], standalone__swiglu_ffn__prompt_kernel_stub4
    s_call_b64 s[4:5], standalone__swiglu_ffn__prompt_kernel_stub5
standalone__swiglu_ffn__prompt_kernel_pw2:
    s_cmp_lg_u32 s3, 3
    s_cbranch_scc1 standalone__swiglu_ffn__prompt_kernel_pw3
    s_call_b64 s[4:5], standalone__swiglu_ffn__prompt_kernel_stub6
standalone__swiglu_ffn__prompt_kernel_pw3:
    s_waitcnt vmcnt(12)
    v_readfirstlane_b32 s45, v61
    s_nop 3
    s_add_u32 s45, s45, 1
    s_or_b32 s45, s45, 0x80000000
    s_cmp_lg_u32 s3, 0
    s_cbranch_scc1 standalone__swiglu_ffn__prompt_kernel_st_p1
    s_lshl_b32 s4, s2, 2
    s_add_u32 s4, s4, 12914688
    v_mov_b32 v2, 0
    v_mov_b32 v3, s45
    s_mov_b64 exec, 1
    buffer_store_dword v3, v2, s[20:23], s4 offen sc1
    s_mov_b64 exec, -1
standalone__swiglu_ffn__prompt_kernel_st_p1:
    s_barrier
    s_branch standalone__swiglu_ffn__prompt_kernel_pg1
.p2align 12
standalone__swiglu_ffn__prompt_kernel_stub1:
    s_setpc_b64 s[4:5]
standalone__swiglu_ffn__prompt_kernel_pg1:
    ds_read_b64_tr_b16 a[64:65], v16 offset:0
    ds_read_b64_tr_b16 a[66:67], v16 offset:512
    ds_read_b64_tr_b16 a[68:69], v16 offset:2048
    ds_read_b64_tr_b16 a[70:71], v16 offset:2560
    ds_read_b64_tr_b16 a[72:73], v17 offset:0
    ds_read_b64_tr_b16 a[74:75], v17 offset:512
    ds_read_b64_tr_b16 a[76:77], v17 offset:2048
    ds_read_b64_tr_b16 a[78:79], v17 offset:2560
    ds_read_b128 a[0:3], v10 offset:0
    ds_read_b128 a[4:7], v10 offset:2048
    ds_read_b128 a[8:11], v10 offset:4096
    ds_read_b128 a[12:15], v10 offset:6144
    ds_read_b128 a[16:19], v10 offset:8192
    ds_read_b128 a[20:23], v10 offset:10240
    ds_read_b128 a[24:27], v10 offset:12288
    ds_read_b128 a[28:31], v10 offset:14336
    s_waitcnt lgkmcnt(0)
    v_mfma_f32_16x16x32_bf16 v[128:131], a[64:67], a[0:3], 0
    ds_read_b64_tr_b16 a[80:81], v16 offset:8192
    v_mfma_f32_16x16x32_bf16 v[132:135], a[68:71], a[0:3], 0
    ds_read_b64_tr_b16 a[82:83], v16 offset:8704
    v_mfma_f32_16x16x32_bf16 v[136:139], a[72:75], a[0:3], 0
    s_add_u32 m0, s43, 98304
    v_mfma_f32_16x16x32_bf16 v[140:143], a[76:79], a[0:3], 0
    ds_read_b64_tr_b16 a[84:85], v16 offset:10240
    buffer_load_dwordx4 v4, s[8:11], s40 offen lds
    v_mfma_f32_16x16x32_bf16 v[144:147], a[64:67], a[4:7], 0
    ds_read_b64_tr_b16 a[86:87], v16 offset:10752
    v_mfma_f32_16x16x32_bf16 v[148:151], a[68:71], a[4:7], 0
    buffer_load_dwordx4 v5, s[8:11], s40 offen offset:1024 lds
    v_mfma_f32_16x16x32_bf16 v[152:155], a[72:75], a[4:7], 0
    ds_read_b64_tr_b16 a[88:89], v17 offset:8192
    buffer_load_dwordx4 v6, s[8:11], s40 offen offset:2048 lds
    v_mfma_f32_16x16x32_bf16 v[156:159], a[76:79], a[4:7], 0
    ds_read_b64_tr_b16 a[90:91], v17 offset:8704
    v_mfma_f32_16x16x32_bf16 v[160:163], a[64:67], a[8:11], 0
    buffer_load_dwordx4 v7, s[8:11], s40 offen offset:3072 lds
    v_mfma_f32_16x16x32_bf16 v[164:167], a[68:71], a[8:11], 0
    ds_read_b64_tr_b16 a[92:93], v17 offset:10240
    s_add_u32 s40, s40, 128
    v_mfma_f32_16x16x32_bf16 v[168:171], a[72:75], a[8:11], 0
    ds_read_b64_tr_b16 a[94:95], v17 offset:10752
    v_mfma_f32_16x16x32_bf16 v[172:175], a[76:79], a[8:11], 0
    s_add_u32 m0, s43, 102400
    v_mfma_f32_16x16x32_bf16 v[176:179], a[64:67], a[12:15], 0
    ds_read_b128 a[32:35], v11 offset:0
    buffer_load_dwordx4 v4, s[8:11], s41 offen lds
    v_mfma_f32_16x16x32_bf16 v[180:183], a[68:71], a[12:15], 0
    ds_read_b128 a[36:39], v11 offset:2048
    v_mfma_f32_16x16x32_bf16 v[184:187], a[72:75], a[12:15], 0
    buffer_load_dwordx4 v5, s[8:11], s41 offen offset:1024 lds
    v_mfma_f32_16x16x32_bf16 v[188:191], a[76:79], a[12:15], 0
    ds_read_b128 a[40:43], v11 offset:4096
    v_mfma_f32_16x16x32_bf16 v[192:195], a[64:67], a[16:19], 0
    ds_read_b128 a[44:47], v11 offset:6144
    buffer_load_dwordx4 v6, s[8:11], s41 offen offset:2048 lds
    v_mfma_f32_16x16x32_bf16 v[196:199], a[68:71], a[16:19], 0
    buffer_load_dwordx4 v7, s[8:11], s41 offen offset:3072 lds
    v_mfma_f32_16x16x32_bf16 v[200:203], a[72:75], a[16:19], 0
    ds_read_b128 a[48:51], v11 offset:8192
    v_mfma_f32_16x16x32_bf16 v[204:207], a[76:79], a[16:19], 0
    ds_read_b128 a[52:55], v11 offset:10240
    s_add_u32 s41, s41, 128
    v_mfma_f32_16x16x32_bf16 v[208:211], a[64:67], a[20:23], 0
    s_add_u32 m0, s44, 98304
    v_mfma_f32_16x16x32_bf16 v[212:215], a[68:71], a[20:23], 0
    ds_read_b128 a[56:59], v11 offset:12288
    v_mfma_f32_16x16x32_bf16 v[216:219], a[72:75], a[20:23], 0
    ds_read_b128 a[60:63], v11 offset:14336
    buffer_load_dwordx4 v8, s[12:15], s42 offen lds
    v_mfma_f32_16x16x32_bf16 v[220:223], a[76:79], a[20:23], 0
    buffer_load_dwordx4 v9, s[12:15], s42 offen offset:1024 lds
    v_mfma_f32_16x16x32_bf16 v[224:227], a[64:67], a[24:27], 0
    v_mfma_f32_16x16x32_bf16 v[228:231], a[68:71], a[24:27], 0
    buffer_load_dwordx4 v8, s[16:19], s42 offen offset:2048 lds
    v_mfma_f32_16x16x32_bf16 v[232:235], a[72:75], a[24:27], 0
    buffer_load_dwordx4 v9, s[16:19], s42 offen offset:3072 lds
    v_mfma_f32_16x16x32_bf16 v[236:239], a[76:79], a[24:27], 0
    v_mfma_f32_16x16x32_bf16 v[240:243], a[64:67], a[28:31], 0
    s_add_u32 s42, s42, 221184
    v_mfma_f32_16x16x32_bf16 v[244:247], a[68:71], a[28:31], 0
    v_mfma_f32_16x16x32_bf16 v[248:251], a[72:75], a[28:31], 0
    v_mfma_f32_16x16x32_bf16 v[252:255], a[76:79], a[28:31], 0
    s_waitcnt vmcnt(12) lgkmcnt(0)
    s_barrier
    v_mfma_f32_16x16x32_bf16 v[128:131], a[80:83], a[32:35], v[128:131]
    ds_read_b64_tr_b16 a[64:65], v18 offset:0
    v_mfma_f32_16x16x32_bf16 v[132:135], a[84:87], a[32:35], v[132:135]
    ds_read_b64_tr_b16 a[66:67], v18 offset:512
    v_mfma_f32_16x16x32_bf16 v[136:139], a[88:91], a[32:35], v[136:139]
    s_add_u32 m0, s43, 0
    v_mfma_f32_16x16x32_bf16 v[140:143], a[92:95], a[32:35], v[140:143]
    ds_read_b64_tr_b16 a[68:69], v18 offset:2048
    v_mfma_f32_16x16x32_bf16 v[144:147], a[80:83], a[36:39], v[144:147]
    ds_read_b64_tr_b16 a[70:71], v18 offset:2560
    v_mfma_f32_16x16x32_bf16 v[148:151], a[84:87], a[36:39], v[148:151]
    buffer_load_dwordx4 v4, s[8:11], s40 offen lds
    v_mfma_f32_16x16x32_bf16 v[152:155], a[88:91], a[36:39], v[152:155]
    ds_read_b64_tr_b16 a[72:73], v19 offset:0
    v_mfma_f32_16x16x32_bf16 v[156:159], a[92:95], a[36:39], v[156:159]
    ds_read_b64_tr_b16 a[74:75], v19 offset:512
    v_mfma_f32_16x16x32_bf16 v[160:163], a[80:83], a[40:43], v[160:163]
    buffer_load_dwordx4 v5, s[8:11], s40 offen offset:1024 lds
    v_mfma_f32_16x16x32_bf16 v[164:167], a[84:87], a[40:43], v[164:167]
    ds_read_b64_tr_b16 a[76:77], v19 offset:2048
    v_mfma_f32_16x16x32_bf16 v[168:171], a[88:91], a[40:43], v[168:171]
    ds_read_b64_tr_b16 a[78:79], v19 offset:2560
    v_mfma_f32_16x16x32_bf16 v[172:175], a[92:95], a[40:43], v[172:175]
    buffer_load_dwordx4 v6, s[8:11], s40 offen offset:2048 lds
    v_mfma_f32_16x16x32_bf16 v[176:179], a[80:83], a[44:47], v[176:179]
    ds_read_b128 a[0:3], v12 offset:0
    v_mfma_f32_16x16x32_bf16 v[180:183], a[84:87], a[44:47], v[180:183]
    ds_read_b128 a[4:7], v12 offset:2048
    v_mfma_f32_16x16x32_bf16 v[184:187], a[88:91], a[44:47], v[184:187]
    buffer_load_dwordx4 v7, s[8:11], s40 offen offset:3072 lds
    v_mfma_f32_16x16x32_bf16 v[188:191], a[92:95], a[44:47], v[188:191]
    ds_read_b128 a[8:11], v12 offset:4096
    v_mfma_f32_16x16x32_bf16 v[192:195], a[80:83], a[48:51], v[192:195]
    ds_read_b128 a[12:15], v12 offset:6144
    v_mfma_f32_16x16x32_bf16 v[196:199], a[84:87], a[48:51], v[196:199]
    s_add_u32 s40, s40, 128
    v_mfma_f32_16x16x32_bf16 v[200:203], a[88:91], a[48:51], v[200:203]
    ds_read_b128 a[16:19], v12 offset:8192
    v_mfma_f32_16x16x32_bf16 v[204:207], a[92:95], a[48:51], v[204:207]
    ds_read_b128 a[20:23], v12 offset:10240
    v_mfma_f32_16x16x32_bf16 v[208:211], a[80:83], a[52:55], v[208:211]
    s_add_u32 m0, s43, 4096
    v_mfma_f32_16x16x32_bf16 v[212:215], a[84:87], a[52:55], v[212:215]
    ds_read_b128 a[24:27], v12 offset:12288
    v_mfma_f32_16x16x32_bf16 v[216:219], a[88:91], a[52:55], v[216:219]
    ds_read_b128 a[28:31], v12 offset:14336
    v_mfma_f32_16x16x32_bf16 v[220:223], a[92:95], a[52:55], v[220:223]
    buffer_load_dwordx4 v4, s[8:11], s41 offen lds
    v_mfma_f32_16x16x32_bf16 v[224:227], a[80:83], a[56:59], v[224:227]
    v_mfma_f32_16x16x32_bf16 v[228:231], a[84:87], a[56:59], v[228:231]
    v_mfma_f32_16x16x32_bf16 v[232:235], a[88:91], a[56:59], v[232:235]
    buffer_load_dwordx4 v5, s[8:11], s41 offen offset:1024 lds
    v_mfma_f32_16x16x32_bf16 v[236:239], a[92:95], a[56:59], v[236:239]
    v_mfma_f32_16x16x32_bf16 v[240:243], a[80:83], a[60:63], v[240:243]
    v_mfma_f32_16x16x32_bf16 v[244:247], a[84:87], a[60:63], v[244:247]
    v_mfma_f32_16x16x32_bf16 v[248:251], a[88:91], a[60:63], v[248:251]
    v_mfma_f32_16x16x32_bf16 v[252:255], a[92:95], a[60:63], v[252:255]
    s_waitcnt lgkmcnt(0)
    v_mfma_f32_16x16x32_bf16 v[128:131], a[64:67], a[0:3], v[128:131]
    ds_read_b64_tr_b16 a[80:81], v18 offset:8192
    v_mfma_f32_16x16x32_bf16 v[132:135], a[68:71], a[0:3], v[132:135]
    ds_read_b64_tr_b16 a[82:83], v18 offset:8704
    v_mfma_f32_16x16x32_bf16 v[136:139], a[72:75], a[0:3], v[136:139]
    buffer_load_dwordx4 v6, s[8:11], s41 offen offset:2048 lds
    v_mfma_f32_16x16x32_bf16 v[140:143], a[76:79], a[0:3], v[140:143]
    ds_read_b64_tr_b16 a[84:85], v18 offset:10240
    v_mfma_f32_16x16x32_bf16 v[144:147], a[64:67], a[4:7], v[144:147]
    ds_read_b64_tr_b16 a[86:87], v18 offset:10752
    v_mfma_f32_16x16x32_bf16 v[148:151], a[68:71], a[4:7], v[148:151]
    buffer_load_dwordx4 v7, s[8:11], s41 offen offset:3072 lds
    v_mfma_f32_16x16x32_bf16 v[152:155], a[72:75], a[4:7], v[152:155]
    ds_read_b64_tr_b16 a[88:89], v19 offset:8192
    v_mfma_f32_16x16x32_bf16 v[156:159], a[76:79], a[4:7], v[156:159]
    ds_read_b64_tr_b16 a[90:91], v19 offset:8704
    v_mfma_f32_16x16x32_bf16 v[160:163], a[64:67], a[8:11], v[160:163]
    s_add_u32 s41, s41, 128
    v_mfma_f32_16x16x32_bf16 v[164:167], a[68:71], a[8:11], v[164:167]
    ds_read_b64_tr_b16 a[92:93], v19 offset:10240
    v_mfma_f32_16x16x32_bf16 v[168:171], a[72:75], a[8:11], v[168:171]
    ds_read_b64_tr_b16 a[94:95], v19 offset:10752
    v_mfma_f32_16x16x32_bf16 v[172:175], a[76:79], a[8:11], v[172:175]
    s_add_u32 m0, s44, 0
    v_mfma_f32_16x16x32_bf16 v[176:179], a[64:67], a[12:15], v[176:179]
    ds_read_b128 a[32:35], v13 offset:0
    v_mfma_f32_16x16x32_bf16 v[180:183], a[68:71], a[12:15], v[180:183]
    ds_read_b128 a[36:39], v13 offset:2048
    v_mfma_f32_16x16x32_bf16 v[184:187], a[72:75], a[12:15], v[184:187]
    buffer_load_dwordx4 v8, s[12:15], s42 offen lds
    v_mfma_f32_16x16x32_bf16 v[188:191], a[76:79], a[12:15], v[188:191]
    ds_read_b128 a[40:43], v13 offset:4096
    v_mfma_f32_16x16x32_bf16 v[192:195], a[64:67], a[16:19], v[192:195]
    ds_read_b128 a[44:47], v13 offset:6144
    v_mfma_f32_16x16x32_bf16 v[196:199], a[68:71], a[16:19], v[196:199]
    buffer_load_dwordx4 v9, s[12:15], s42 offen offset:1024 lds
    v_mfma_f32_16x16x32_bf16 v[200:203], a[72:75], a[16:19], v[200:203]
    ds_read_b128 a[48:51], v13 offset:8192
    v_mfma_f32_16x16x32_bf16 v[204:207], a[76:79], a[16:19], v[204:207]
    ds_read_b128 a[52:55], v13 offset:10240
    v_mfma_f32_16x16x32_bf16 v[208:211], a[64:67], a[20:23], v[208:211]
    buffer_load_dwordx4 v8, s[16:19], s42 offen offset:2048 lds
    v_mfma_f32_16x16x32_bf16 v[212:215], a[68:71], a[20:23], v[212:215]
    ds_read_b128 a[56:59], v13 offset:12288
    v_mfma_f32_16x16x32_bf16 v[216:219], a[72:75], a[20:23], v[216:219]
    ds_read_b128 a[60:63], v13 offset:14336
    v_mfma_f32_16x16x32_bf16 v[220:223], a[76:79], a[20:23], v[220:223]
    buffer_load_dwordx4 v9, s[16:19], s42 offen offset:3072 lds
    v_mfma_f32_16x16x32_bf16 v[224:227], a[64:67], a[24:27], v[224:227]
    v_mfma_f32_16x16x32_bf16 v[228:231], a[68:71], a[24:27], v[228:231]
    v_mfma_f32_16x16x32_bf16 v[232:235], a[72:75], a[24:27], v[232:235]
    s_add_u32 s42, s42, 221184
    v_mfma_f32_16x16x32_bf16 v[236:239], a[76:79], a[24:27], v[236:239]
    v_mfma_f32_16x16x32_bf16 v[240:243], a[64:67], a[28:31], v[240:243]
    v_mfma_f32_16x16x32_bf16 v[244:247], a[68:71], a[28:31], v[244:247]
    v_mfma_f32_16x16x32_bf16 v[248:251], a[72:75], a[28:31], v[248:251]
    v_mfma_f32_16x16x32_bf16 v[252:255], a[76:79], a[28:31], v[252:255]
    s_waitcnt vmcnt(12) lgkmcnt(0)
    s_barrier
    v_mfma_f32_16x16x32_bf16 v[128:131], a[80:83], a[32:35], v[128:131]
    ds_read_b64_tr_b16 a[64:65], v20 offset:0
    v_mfma_f32_16x16x32_bf16 v[132:135], a[84:87], a[32:35], v[132:135]
    ds_read_b64_tr_b16 a[66:67], v20 offset:512
    v_mfma_f32_16x16x32_bf16 v[136:139], a[88:91], a[32:35], v[136:139]
    s_add_u32 m0, s43, 49152
    v_mfma_f32_16x16x32_bf16 v[140:143], a[92:95], a[32:35], v[140:143]
    ds_read_b64_tr_b16 a[68:69], v20 offset:2048
    v_mfma_f32_16x16x32_bf16 v[144:147], a[80:83], a[36:39], v[144:147]
    ds_read_b64_tr_b16 a[70:71], v20 offset:2560
    v_mfma_f32_16x16x32_bf16 v[148:151], a[84:87], a[36:39], v[148:151]
    buffer_load_dwordx4 v4, s[8:11], s40 offen lds
    v_mfma_f32_16x16x32_bf16 v[152:155], a[88:91], a[36:39], v[152:155]
    ds_read_b64_tr_b16 a[72:73], v21 offset:0
    v_mfma_f32_16x16x32_bf16 v[156:159], a[92:95], a[36:39], v[156:159]
    ds_read_b64_tr_b16 a[74:75], v21 offset:512
    v_mfma_f32_16x16x32_bf16 v[160:163], a[80:83], a[40:43], v[160:163]
    buffer_load_dwordx4 v5, s[8:11], s40 offen offset:1024 lds
    v_mfma_f32_16x16x32_bf16 v[164:167], a[84:87], a[40:43], v[164:167]
    ds_read_b64_tr_b16 a[76:77], v21 offset:2048
    v_mfma_f32_16x16x32_bf16 v[168:171], a[88:91], a[40:43], v[168:171]
    ds_read_b64_tr_b16 a[78:79], v21 offset:2560
    v_mfma_f32_16x16x32_bf16 v[172:175], a[92:95], a[40:43], v[172:175]
    buffer_load_dwordx4 v6, s[8:11], s40 offen offset:2048 lds
    v_mfma_f32_16x16x32_bf16 v[176:179], a[80:83], a[44:47], v[176:179]
    ds_read_b128 a[0:3], v14 offset:0
    v_mfma_f32_16x16x32_bf16 v[180:183], a[84:87], a[44:47], v[180:183]
    ds_read_b128 a[4:7], v14 offset:2048
    v_mfma_f32_16x16x32_bf16 v[184:187], a[88:91], a[44:47], v[184:187]
    buffer_load_dwordx4 v7, s[8:11], s40 offen offset:3072 lds
    v_mfma_f32_16x16x32_bf16 v[188:191], a[92:95], a[44:47], v[188:191]
    ds_read_b128 a[8:11], v14 offset:4096
    v_mfma_f32_16x16x32_bf16 v[192:195], a[80:83], a[48:51], v[192:195]
    ds_read_b128 a[12:15], v14 offset:6144
    v_mfma_f32_16x16x32_bf16 v[196:199], a[84:87], a[48:51], v[196:199]
    s_add_u32 s40, s40, 128
    v_mfma_f32_16x16x32_bf16 v[200:203], a[88:91], a[48:51], v[200:203]
    ds_read_b128 a[16:19], v14 offset:8192
    v_mfma_f32_16x16x32_bf16 v[204:207], a[92:95], a[48:51], v[204:207]
    ds_read_b128 a[20:23], v14 offset:10240
    v_mfma_f32_16x16x32_bf16 v[208:211], a[80:83], a[52:55], v[208:211]
    s_add_u32 m0, s43, 53248
    v_mfma_f32_16x16x32_bf16 v[212:215], a[84:87], a[52:55], v[212:215]
    ds_read_b128 a[24:27], v14 offset:12288
    v_mfma_f32_16x16x32_bf16 v[216:219], a[88:91], a[52:55], v[216:219]
    ds_read_b128 a[28:31], v14 offset:14336
    v_mfma_f32_16x16x32_bf16 v[220:223], a[92:95], a[52:55], v[220:223]
    buffer_load_dwordx4 v4, s[8:11], s41 offen lds
    v_mfma_f32_16x16x32_bf16 v[224:227], a[80:83], a[56:59], v[224:227]
    v_mfma_f32_16x16x32_bf16 v[228:231], a[84:87], a[56:59], v[228:231]
    v_mfma_f32_16x16x32_bf16 v[232:235], a[88:91], a[56:59], v[232:235]
    buffer_load_dwordx4 v5, s[8:11], s41 offen offset:1024 lds
    v_mfma_f32_16x16x32_bf16 v[236:239], a[92:95], a[56:59], v[236:239]
    v_mfma_f32_16x16x32_bf16 v[240:243], a[80:83], a[60:63], v[240:243]
    v_mfma_f32_16x16x32_bf16 v[244:247], a[84:87], a[60:63], v[244:247]
    v_mfma_f32_16x16x32_bf16 v[248:251], a[88:91], a[60:63], v[248:251]
    v_mfma_f32_16x16x32_bf16 v[252:255], a[92:95], a[60:63], v[252:255]
    s_waitcnt lgkmcnt(0)
    v_mfma_f32_16x16x32_bf16 v[128:131], a[64:67], a[0:3], v[128:131]
    ds_read_b64_tr_b16 a[80:81], v20 offset:8192
    v_mfma_f32_16x16x32_bf16 v[132:135], a[68:71], a[0:3], v[132:135]
    ds_read_b64_tr_b16 a[82:83], v20 offset:8704
    v_mfma_f32_16x16x32_bf16 v[136:139], a[72:75], a[0:3], v[136:139]
    buffer_load_dwordx4 v6, s[8:11], s41 offen offset:2048 lds
    v_mfma_f32_16x16x32_bf16 v[140:143], a[76:79], a[0:3], v[140:143]
    ds_read_b64_tr_b16 a[84:85], v20 offset:10240
    v_mfma_f32_16x16x32_bf16 v[144:147], a[64:67], a[4:7], v[144:147]
    ds_read_b64_tr_b16 a[86:87], v20 offset:10752
    v_mfma_f32_16x16x32_bf16 v[148:151], a[68:71], a[4:7], v[148:151]
    buffer_load_dwordx4 v7, s[8:11], s41 offen offset:3072 lds
    v_mfma_f32_16x16x32_bf16 v[152:155], a[72:75], a[4:7], v[152:155]
    ds_read_b64_tr_b16 a[88:89], v21 offset:8192
    v_mfma_f32_16x16x32_bf16 v[156:159], a[76:79], a[4:7], v[156:159]
    ds_read_b64_tr_b16 a[90:91], v21 offset:8704
    v_mfma_f32_16x16x32_bf16 v[160:163], a[64:67], a[8:11], v[160:163]
    s_add_u32 s41, s41, 128
    v_mfma_f32_16x16x32_bf16 v[164:167], a[68:71], a[8:11], v[164:167]
    ds_read_b64_tr_b16 a[92:93], v21 offset:10240
    v_mfma_f32_16x16x32_bf16 v[168:171], a[72:75], a[8:11], v[168:171]
    ds_read_b64_tr_b16 a[94:95], v21 offset:10752
    v_mfma_f32_16x16x32_bf16 v[172:175], a[76:79], a[8:11], v[172:175]
    s_add_u32 m0, s44, 49152
    v_mfma_f32_16x16x32_bf16 v[176:179], a[64:67], a[12:15], v[176:179]
    ds_read_b128 a[32:35], v15 offset:0
    v_mfma_f32_16x16x32_bf16 v[180:183], a[68:71], a[12:15], v[180:183]
    ds_read_b128 a[36:39], v15 offset:2048
    v_mfma_f32_16x16x32_bf16 v[184:187], a[72:75], a[12:15], v[184:187]
    buffer_load_dwordx4 v8, s[12:15], s42 offen lds
    v_mfma_f32_16x16x32_bf16 v[188:191], a[76:79], a[12:15], v[188:191]
    ds_read_b128 a[40:43], v15 offset:4096
    v_mfma_f32_16x16x32_bf16 v[192:195], a[64:67], a[16:19], v[192:195]
    ds_read_b128 a[44:47], v15 offset:6144
    v_mfma_f32_16x16x32_bf16 v[196:199], a[68:71], a[16:19], v[196:199]
    buffer_load_dwordx4 v9, s[12:15], s42 offen offset:1024 lds
    v_mfma_f32_16x16x32_bf16 v[200:203], a[72:75], a[16:19], v[200:203]
    ds_read_b128 a[48:51], v15 offset:8192
    v_mfma_f32_16x16x32_bf16 v[204:207], a[76:79], a[16:19], v[204:207]
    ds_read_b128 a[52:55], v15 offset:10240
    v_mfma_f32_16x16x32_bf16 v[208:211], a[64:67], a[20:23], v[208:211]
    buffer_load_dwordx4 v8, s[16:19], s42 offen offset:2048 lds
    v_mfma_f32_16x16x32_bf16 v[212:215], a[68:71], a[20:23], v[212:215]
    ds_read_b128 a[56:59], v15 offset:12288
    v_mfma_f32_16x16x32_bf16 v[216:219], a[72:75], a[20:23], v[216:219]
    ds_read_b128 a[60:63], v15 offset:14336
    v_mfma_f32_16x16x32_bf16 v[220:223], a[76:79], a[20:23], v[220:223]
    buffer_load_dwordx4 v9, s[16:19], s42 offen offset:3072 lds
    v_mfma_f32_16x16x32_bf16 v[224:227], a[64:67], a[24:27], v[224:227]
    v_mfma_f32_16x16x32_bf16 v[228:231], a[68:71], a[24:27], v[228:231]
    v_mfma_f32_16x16x32_bf16 v[232:235], a[72:75], a[24:27], v[232:235]
    s_add_u32 s42, s42, 221184
    v_mfma_f32_16x16x32_bf16 v[236:239], a[76:79], a[24:27], v[236:239]
    v_mfma_f32_16x16x32_bf16 v[240:243], a[64:67], a[28:31], v[240:243]
    v_mfma_f32_16x16x32_bf16 v[244:247], a[68:71], a[28:31], v[244:247]
    v_mfma_f32_16x16x32_bf16 v[248:251], a[72:75], a[28:31], v[248:251]
    v_mfma_f32_16x16x32_bf16 v[252:255], a[76:79], a[28:31], v[252:255]
    s_waitcnt vmcnt(12) lgkmcnt(0)
    s_barrier
    v_mfma_f32_16x16x32_bf16 v[128:131], a[80:83], a[32:35], v[128:131]
    ds_read_b64_tr_b16 a[64:65], v16 offset:0
    v_mfma_f32_16x16x32_bf16 v[132:135], a[84:87], a[32:35], v[132:135]
    ds_read_b64_tr_b16 a[66:67], v16 offset:512
    v_mfma_f32_16x16x32_bf16 v[136:139], a[88:91], a[32:35], v[136:139]
    s_add_u32 m0, s43, 98304
    v_mfma_f32_16x16x32_bf16 v[140:143], a[92:95], a[32:35], v[140:143]
    ds_read_b64_tr_b16 a[68:69], v16 offset:2048
    v_mfma_f32_16x16x32_bf16 v[144:147], a[80:83], a[36:39], v[144:147]
    ds_read_b64_tr_b16 a[70:71], v16 offset:2560
    v_mfma_f32_16x16x32_bf16 v[148:151], a[84:87], a[36:39], v[148:151]
    buffer_load_dwordx4 v4, s[8:11], s40 offen lds
    v_mfma_f32_16x16x32_bf16 v[152:155], a[88:91], a[36:39], v[152:155]
    ds_read_b64_tr_b16 a[72:73], v17 offset:0
    v_mfma_f32_16x16x32_bf16 v[156:159], a[92:95], a[36:39], v[156:159]
    ds_read_b64_tr_b16 a[74:75], v17 offset:512
    v_mfma_f32_16x16x32_bf16 v[160:163], a[80:83], a[40:43], v[160:163]
    buffer_load_dwordx4 v5, s[8:11], s40 offen offset:1024 lds
    v_mfma_f32_16x16x32_bf16 v[164:167], a[84:87], a[40:43], v[164:167]
    ds_read_b64_tr_b16 a[76:77], v17 offset:2048
    v_mfma_f32_16x16x32_bf16 v[168:171], a[88:91], a[40:43], v[168:171]
    ds_read_b64_tr_b16 a[78:79], v17 offset:2560
    v_mfma_f32_16x16x32_bf16 v[172:175], a[92:95], a[40:43], v[172:175]
    buffer_load_dwordx4 v6, s[8:11], s40 offen offset:2048 lds
    v_mfma_f32_16x16x32_bf16 v[176:179], a[80:83], a[44:47], v[176:179]
    ds_read_b128 a[0:3], v10 offset:0
    v_mfma_f32_16x16x32_bf16 v[180:183], a[84:87], a[44:47], v[180:183]
    ds_read_b128 a[4:7], v10 offset:2048
    v_mfma_f32_16x16x32_bf16 v[184:187], a[88:91], a[44:47], v[184:187]
    buffer_load_dwordx4 v7, s[8:11], s40 offen offset:3072 lds
    v_mfma_f32_16x16x32_bf16 v[188:191], a[92:95], a[44:47], v[188:191]
    ds_read_b128 a[8:11], v10 offset:4096
    v_mfma_f32_16x16x32_bf16 v[192:195], a[80:83], a[48:51], v[192:195]
    ds_read_b128 a[12:15], v10 offset:6144
    v_mfma_f32_16x16x32_bf16 v[196:199], a[84:87], a[48:51], v[196:199]
    s_add_u32 s40, s40, 128
    v_mfma_f32_16x16x32_bf16 v[200:203], a[88:91], a[48:51], v[200:203]
    ds_read_b128 a[16:19], v10 offset:8192
    v_mfma_f32_16x16x32_bf16 v[204:207], a[92:95], a[48:51], v[204:207]
    ds_read_b128 a[20:23], v10 offset:10240
    v_mfma_f32_16x16x32_bf16 v[208:211], a[80:83], a[52:55], v[208:211]
    s_add_u32 m0, s43, 102400
    v_mfma_f32_16x16x32_bf16 v[212:215], a[84:87], a[52:55], v[212:215]
    ds_read_b128 a[24:27], v10 offset:12288
    v_mfma_f32_16x16x32_bf16 v[216:219], a[88:91], a[52:55], v[216:219]
    ds_read_b128 a[28:31], v10 offset:14336
    v_mfma_f32_16x16x32_bf16 v[220:223], a[92:95], a[52:55], v[220:223]
    buffer_load_dwordx4 v4, s[8:11], s41 offen lds
    v_mfma_f32_16x16x32_bf16 v[224:227], a[80:83], a[56:59], v[224:227]
    v_mfma_f32_16x16x32_bf16 v[228:231], a[84:87], a[56:59], v[228:231]
    v_mfma_f32_16x16x32_bf16 v[232:235], a[88:91], a[56:59], v[232:235]
    buffer_load_dwordx4 v5, s[8:11], s41 offen offset:1024 lds
    v_mfma_f32_16x16x32_bf16 v[236:239], a[92:95], a[56:59], v[236:239]
    v_mfma_f32_16x16x32_bf16 v[240:243], a[80:83], a[60:63], v[240:243]
    v_mfma_f32_16x16x32_bf16 v[244:247], a[84:87], a[60:63], v[244:247]
    v_mfma_f32_16x16x32_bf16 v[248:251], a[88:91], a[60:63], v[248:251]
    v_mfma_f32_16x16x32_bf16 v[252:255], a[92:95], a[60:63], v[252:255]
    s_waitcnt lgkmcnt(0)
    v_mfma_f32_16x16x32_bf16 v[128:131], a[64:67], a[0:3], v[128:131]
    ds_read_b64_tr_b16 a[80:81], v16 offset:8192
    v_mfma_f32_16x16x32_bf16 v[132:135], a[68:71], a[0:3], v[132:135]
    ds_read_b64_tr_b16 a[82:83], v16 offset:8704
    v_mfma_f32_16x16x32_bf16 v[136:139], a[72:75], a[0:3], v[136:139]
    buffer_load_dwordx4 v6, s[8:11], s41 offen offset:2048 lds
    v_mfma_f32_16x16x32_bf16 v[140:143], a[76:79], a[0:3], v[140:143]
    ds_read_b64_tr_b16 a[84:85], v16 offset:10240
    v_mfma_f32_16x16x32_bf16 v[144:147], a[64:67], a[4:7], v[144:147]
    ds_read_b64_tr_b16 a[86:87], v16 offset:10752
    v_mfma_f32_16x16x32_bf16 v[148:151], a[68:71], a[4:7], v[148:151]
    buffer_load_dwordx4 v7, s[8:11], s41 offen offset:3072 lds
    v_mfma_f32_16x16x32_bf16 v[152:155], a[72:75], a[4:7], v[152:155]
    ds_read_b64_tr_b16 a[88:89], v17 offset:8192
    v_mfma_f32_16x16x32_bf16 v[156:159], a[76:79], a[4:7], v[156:159]
    ds_read_b64_tr_b16 a[90:91], v17 offset:8704
    v_mfma_f32_16x16x32_bf16 v[160:163], a[64:67], a[8:11], v[160:163]
    s_add_u32 s41, s41, 128
    v_mfma_f32_16x16x32_bf16 v[164:167], a[68:71], a[8:11], v[164:167]
    ds_read_b64_tr_b16 a[92:93], v17 offset:10240
    v_mfma_f32_16x16x32_bf16 v[168:171], a[72:75], a[8:11], v[168:171]
    ds_read_b64_tr_b16 a[94:95], v17 offset:10752
    v_mfma_f32_16x16x32_bf16 v[172:175], a[76:79], a[8:11], v[172:175]
    s_add_u32 m0, s44, 98304
    v_mfma_f32_16x16x32_bf16 v[176:179], a[64:67], a[12:15], v[176:179]
    ds_read_b128 a[32:35], v11 offset:0
    v_mfma_f32_16x16x32_bf16 v[180:183], a[68:71], a[12:15], v[180:183]
    ds_read_b128 a[36:39], v11 offset:2048
    v_mfma_f32_16x16x32_bf16 v[184:187], a[72:75], a[12:15], v[184:187]
    buffer_load_dwordx4 v8, s[12:15], s42 offen lds
    v_mfma_f32_16x16x32_bf16 v[188:191], a[76:79], a[12:15], v[188:191]
    ds_read_b128 a[40:43], v11 offset:4096
    v_mfma_f32_16x16x32_bf16 v[192:195], a[64:67], a[16:19], v[192:195]
    ds_read_b128 a[44:47], v11 offset:6144
    v_mfma_f32_16x16x32_bf16 v[196:199], a[68:71], a[16:19], v[196:199]
    buffer_load_dwordx4 v9, s[12:15], s42 offen offset:1024 lds
    v_mfma_f32_16x16x32_bf16 v[200:203], a[72:75], a[16:19], v[200:203]
    ds_read_b128 a[48:51], v11 offset:8192
    v_mfma_f32_16x16x32_bf16 v[204:207], a[76:79], a[16:19], v[204:207]
    ds_read_b128 a[52:55], v11 offset:10240
    v_mfma_f32_16x16x32_bf16 v[208:211], a[64:67], a[20:23], v[208:211]
    buffer_load_dwordx4 v8, s[16:19], s42 offen offset:2048 lds
    v_mfma_f32_16x16x32_bf16 v[212:215], a[68:71], a[20:23], v[212:215]
    ds_read_b128 a[56:59], v11 offset:12288
    v_mfma_f32_16x16x32_bf16 v[216:219], a[72:75], a[20:23], v[216:219]
    ds_read_b128 a[60:63], v11 offset:14336
    v_mfma_f32_16x16x32_bf16 v[220:223], a[76:79], a[20:23], v[220:223]
    buffer_load_dwordx4 v9, s[16:19], s42 offen offset:3072 lds
    v_mfma_f32_16x16x32_bf16 v[224:227], a[64:67], a[24:27], v[224:227]
    v_mfma_f32_16x16x32_bf16 v[228:231], a[68:71], a[24:27], v[228:231]
    v_mfma_f32_16x16x32_bf16 v[232:235], a[72:75], a[24:27], v[232:235]
    s_add_u32 s42, s42, 221184
    v_mfma_f32_16x16x32_bf16 v[236:239], a[76:79], a[24:27], v[236:239]
    v_mfma_f32_16x16x32_bf16 v[240:243], a[64:67], a[28:31], v[240:243]
    v_mfma_f32_16x16x32_bf16 v[244:247], a[68:71], a[28:31], v[244:247]
    v_mfma_f32_16x16x32_bf16 v[248:251], a[72:75], a[28:31], v[248:251]
    v_mfma_f32_16x16x32_bf16 v[252:255], a[76:79], a[28:31], v[252:255]
    s_waitcnt vmcnt(12) lgkmcnt(0)
    s_barrier
    v_mfma_f32_16x16x32_bf16 v[128:131], a[80:83], a[32:35], v[128:131]
    ds_read_b64_tr_b16 a[64:65], v18 offset:0
    v_mfma_f32_16x16x32_bf16 v[132:135], a[84:87], a[32:35], v[132:135]
    ds_read_b64_tr_b16 a[66:67], v18 offset:512
    v_mfma_f32_16x16x32_bf16 v[136:139], a[88:91], a[32:35], v[136:139]
    s_add_u32 m0, s43, 0
    v_mfma_f32_16x16x32_bf16 v[140:143], a[92:95], a[32:35], v[140:143]
    ds_read_b64_tr_b16 a[68:69], v18 offset:2048
    v_mfma_f32_16x16x32_bf16 v[144:147], a[80:83], a[36:39], v[144:147]
    ds_read_b64_tr_b16 a[70:71], v18 offset:2560
    v_mfma_f32_16x16x32_bf16 v[148:151], a[84:87], a[36:39], v[148:151]
    buffer_load_dwordx4 v4, s[8:11], s40 offen lds
    v_mfma_f32_16x16x32_bf16 v[152:155], a[88:91], a[36:39], v[152:155]
    ds_read_b64_tr_b16 a[72:73], v19 offset:0
    v_mfma_f32_16x16x32_bf16 v[156:159], a[92:95], a[36:39], v[156:159]
    ds_read_b64_tr_b16 a[74:75], v19 offset:512
    v_mfma_f32_16x16x32_bf16 v[160:163], a[80:83], a[40:43], v[160:163]
    buffer_load_dwordx4 v5, s[8:11], s40 offen offset:1024 lds
    v_mfma_f32_16x16x32_bf16 v[164:167], a[84:87], a[40:43], v[164:167]
    ds_read_b64_tr_b16 a[76:77], v19 offset:2048
    v_mfma_f32_16x16x32_bf16 v[168:171], a[88:91], a[40:43], v[168:171]
    ds_read_b64_tr_b16 a[78:79], v19 offset:2560
    v_mfma_f32_16x16x32_bf16 v[172:175], a[92:95], a[40:43], v[172:175]
    buffer_load_dwordx4 v6, s[8:11], s40 offen offset:2048 lds
    v_mfma_f32_16x16x32_bf16 v[176:179], a[80:83], a[44:47], v[176:179]
    ds_read_b128 a[0:3], v12 offset:0
    v_mfma_f32_16x16x32_bf16 v[180:183], a[84:87], a[44:47], v[180:183]
    ds_read_b128 a[4:7], v12 offset:2048
    v_mfma_f32_16x16x32_bf16 v[184:187], a[88:91], a[44:47], v[184:187]
    buffer_load_dwordx4 v7, s[8:11], s40 offen offset:3072 lds
    v_mfma_f32_16x16x32_bf16 v[188:191], a[92:95], a[44:47], v[188:191]
    ds_read_b128 a[8:11], v12 offset:4096
    v_mfma_f32_16x16x32_bf16 v[192:195], a[80:83], a[48:51], v[192:195]
    ds_read_b128 a[12:15], v12 offset:6144
    v_mfma_f32_16x16x32_bf16 v[196:199], a[84:87], a[48:51], v[196:199]
    s_add_u32 s40, s40, 128
    v_mfma_f32_16x16x32_bf16 v[200:203], a[88:91], a[48:51], v[200:203]
    ds_read_b128 a[16:19], v12 offset:8192
    v_mfma_f32_16x16x32_bf16 v[204:207], a[92:95], a[48:51], v[204:207]
    ds_read_b128 a[20:23], v12 offset:10240
    v_mfma_f32_16x16x32_bf16 v[208:211], a[80:83], a[52:55], v[208:211]
    s_add_u32 m0, s43, 4096
    v_mfma_f32_16x16x32_bf16 v[212:215], a[84:87], a[52:55], v[212:215]
    ds_read_b128 a[24:27], v12 offset:12288
    v_mfma_f32_16x16x32_bf16 v[216:219], a[88:91], a[52:55], v[216:219]
    ds_read_b128 a[28:31], v12 offset:14336
    v_mfma_f32_16x16x32_bf16 v[220:223], a[92:95], a[52:55], v[220:223]
    buffer_load_dwordx4 v4, s[8:11], s41 offen lds
    v_mfma_f32_16x16x32_bf16 v[224:227], a[80:83], a[56:59], v[224:227]
    v_mfma_f32_16x16x32_bf16 v[228:231], a[84:87], a[56:59], v[228:231]
    v_mfma_f32_16x16x32_bf16 v[232:235], a[88:91], a[56:59], v[232:235]
    buffer_load_dwordx4 v5, s[8:11], s41 offen offset:1024 lds
    v_mfma_f32_16x16x32_bf16 v[236:239], a[92:95], a[56:59], v[236:239]
    v_mfma_f32_16x16x32_bf16 v[240:243], a[80:83], a[60:63], v[240:243]
    v_mfma_f32_16x16x32_bf16 v[244:247], a[84:87], a[60:63], v[244:247]
    v_mfma_f32_16x16x32_bf16 v[248:251], a[88:91], a[60:63], v[248:251]
    v_mfma_f32_16x16x32_bf16 v[252:255], a[92:95], a[60:63], v[252:255]
    s_branch standalone__swiglu_ffn__prompt_kernel_pg2
.p2align 12
standalone__swiglu_ffn__prompt_kernel_stub2:
    s_setpc_b64 s[4:5]
standalone__swiglu_ffn__prompt_kernel_pg2:
    s_waitcnt lgkmcnt(0)
    v_mfma_f32_16x16x32_bf16 v[128:131], a[64:67], a[0:3], v[128:131]
    ds_read_b64_tr_b16 a[80:81], v18 offset:8192
    v_mfma_f32_16x16x32_bf16 v[132:135], a[68:71], a[0:3], v[132:135]
    ds_read_b64_tr_b16 a[82:83], v18 offset:8704
    v_mfma_f32_16x16x32_bf16 v[136:139], a[72:75], a[0:3], v[136:139]
    buffer_load_dwordx4 v6, s[8:11], s41 offen offset:2048 lds
    v_mfma_f32_16x16x32_bf16 v[140:143], a[76:79], a[0:3], v[140:143]
    ds_read_b64_tr_b16 a[84:85], v18 offset:10240
    v_mfma_f32_16x16x32_bf16 v[144:147], a[64:67], a[4:7], v[144:147]
    ds_read_b64_tr_b16 a[86:87], v18 offset:10752
    v_mfma_f32_16x16x32_bf16 v[148:151], a[68:71], a[4:7], v[148:151]
    buffer_load_dwordx4 v7, s[8:11], s41 offen offset:3072 lds
    v_mfma_f32_16x16x32_bf16 v[152:155], a[72:75], a[4:7], v[152:155]
    ds_read_b64_tr_b16 a[88:89], v19 offset:8192
    v_mfma_f32_16x16x32_bf16 v[156:159], a[76:79], a[4:7], v[156:159]
    ds_read_b64_tr_b16 a[90:91], v19 offset:8704
    v_mfma_f32_16x16x32_bf16 v[160:163], a[64:67], a[8:11], v[160:163]
    s_add_u32 s41, s41, 128
    v_mfma_f32_16x16x32_bf16 v[164:167], a[68:71], a[8:11], v[164:167]
    ds_read_b64_tr_b16 a[92:93], v19 offset:10240
    v_mfma_f32_16x16x32_bf16 v[168:171], a[72:75], a[8:11], v[168:171]
    ds_read_b64_tr_b16 a[94:95], v19 offset:10752
    v_mfma_f32_16x16x32_bf16 v[172:175], a[76:79], a[8:11], v[172:175]
    s_add_u32 m0, s44, 0
    v_mfma_f32_16x16x32_bf16 v[176:179], a[64:67], a[12:15], v[176:179]
    ds_read_b128 a[32:35], v13 offset:0
    v_mfma_f32_16x16x32_bf16 v[180:183], a[68:71], a[12:15], v[180:183]
    ds_read_b128 a[36:39], v13 offset:2048
    v_mfma_f32_16x16x32_bf16 v[184:187], a[72:75], a[12:15], v[184:187]
    buffer_load_dwordx4 v8, s[12:15], s42 offen lds
    v_mfma_f32_16x16x32_bf16 v[188:191], a[76:79], a[12:15], v[188:191]
    ds_read_b128 a[40:43], v13 offset:4096
    v_mfma_f32_16x16x32_bf16 v[192:195], a[64:67], a[16:19], v[192:195]
    ds_read_b128 a[44:47], v13 offset:6144
    v_mfma_f32_16x16x32_bf16 v[196:199], a[68:71], a[16:19], v[196:199]
    buffer_load_dwordx4 v9, s[12:15], s42 offen offset:1024 lds
    v_mfma_f32_16x16x32_bf16 v[200:203], a[72:75], a[16:19], v[200:203]
    ds_read_b128 a[48:51], v13 offset:8192
    v_mfma_f32_16x16x32_bf16 v[204:207], a[76:79], a[16:19], v[204:207]
    ds_read_b128 a[52:55], v13 offset:10240
    v_mfma_f32_16x16x32_bf16 v[208:211], a[64:67], a[20:23], v[208:211]
    buffer_load_dwordx4 v8, s[16:19], s42 offen offset:2048 lds
    v_mfma_f32_16x16x32_bf16 v[212:215], a[68:71], a[20:23], v[212:215]
    ds_read_b128 a[56:59], v13 offset:12288
    v_mfma_f32_16x16x32_bf16 v[216:219], a[72:75], a[20:23], v[216:219]
    ds_read_b128 a[60:63], v13 offset:14336
    v_mfma_f32_16x16x32_bf16 v[220:223], a[76:79], a[20:23], v[220:223]
    buffer_load_dwordx4 v9, s[16:19], s42 offen offset:3072 lds
    v_mfma_f32_16x16x32_bf16 v[224:227], a[64:67], a[24:27], v[224:227]
    v_mfma_f32_16x16x32_bf16 v[228:231], a[68:71], a[24:27], v[228:231]
    v_mfma_f32_16x16x32_bf16 v[232:235], a[72:75], a[24:27], v[232:235]
    s_add_u32 s42, s42, 221184
    v_mfma_f32_16x16x32_bf16 v[236:239], a[76:79], a[24:27], v[236:239]
    v_mfma_f32_16x16x32_bf16 v[240:243], a[64:67], a[28:31], v[240:243]
    v_mfma_f32_16x16x32_bf16 v[244:247], a[68:71], a[28:31], v[244:247]
    v_mfma_f32_16x16x32_bf16 v[248:251], a[72:75], a[28:31], v[248:251]
    v_mfma_f32_16x16x32_bf16 v[252:255], a[76:79], a[28:31], v[252:255]
    s_waitcnt vmcnt(12) lgkmcnt(0)
    s_barrier
    v_mfma_f32_16x16x32_bf16 v[128:131], a[80:83], a[32:35], v[128:131]
    ds_read_b64_tr_b16 a[64:65], v20 offset:0
    v_mfma_f32_16x16x32_bf16 v[132:135], a[84:87], a[32:35], v[132:135]
    ds_read_b64_tr_b16 a[66:67], v20 offset:512
    v_mfma_f32_16x16x32_bf16 v[136:139], a[88:91], a[32:35], v[136:139]
    s_add_u32 m0, s43, 49152
    v_mfma_f32_16x16x32_bf16 v[140:143], a[92:95], a[32:35], v[140:143]
    ds_read_b64_tr_b16 a[68:69], v20 offset:2048
    v_mfma_f32_16x16x32_bf16 v[144:147], a[80:83], a[36:39], v[144:147]
    ds_read_b64_tr_b16 a[70:71], v20 offset:2560
    v_mfma_f32_16x16x32_bf16 v[148:151], a[84:87], a[36:39], v[148:151]
    buffer_load_dwordx4 v4, s[8:11], s40 offen lds
    v_mfma_f32_16x16x32_bf16 v[152:155], a[88:91], a[36:39], v[152:155]
    ds_read_b64_tr_b16 a[72:73], v21 offset:0
    v_mfma_f32_16x16x32_bf16 v[156:159], a[92:95], a[36:39], v[156:159]
    ds_read_b64_tr_b16 a[74:75], v21 offset:512
    v_mfma_f32_16x16x32_bf16 v[160:163], a[80:83], a[40:43], v[160:163]
    buffer_load_dwordx4 v5, s[8:11], s40 offen offset:1024 lds
    v_mfma_f32_16x16x32_bf16 v[164:167], a[84:87], a[40:43], v[164:167]
    ds_read_b64_tr_b16 a[76:77], v21 offset:2048
    v_mfma_f32_16x16x32_bf16 v[168:171], a[88:91], a[40:43], v[168:171]
    ds_read_b64_tr_b16 a[78:79], v21 offset:2560
    v_mfma_f32_16x16x32_bf16 v[172:175], a[92:95], a[40:43], v[172:175]
    buffer_load_dwordx4 v6, s[8:11], s40 offen offset:2048 lds
    v_mfma_f32_16x16x32_bf16 v[176:179], a[80:83], a[44:47], v[176:179]
    ds_read_b128 a[0:3], v14 offset:0
    v_mfma_f32_16x16x32_bf16 v[180:183], a[84:87], a[44:47], v[180:183]
    ds_read_b128 a[4:7], v14 offset:2048
    v_mfma_f32_16x16x32_bf16 v[184:187], a[88:91], a[44:47], v[184:187]
    buffer_load_dwordx4 v7, s[8:11], s40 offen offset:3072 lds
    v_mfma_f32_16x16x32_bf16 v[188:191], a[92:95], a[44:47], v[188:191]
    ds_read_b128 a[8:11], v14 offset:4096
    v_mfma_f32_16x16x32_bf16 v[192:195], a[80:83], a[48:51], v[192:195]
    ds_read_b128 a[12:15], v14 offset:6144
    v_mfma_f32_16x16x32_bf16 v[196:199], a[84:87], a[48:51], v[196:199]
    s_add_u32 s40, s40, 128
    v_mfma_f32_16x16x32_bf16 v[200:203], a[88:91], a[48:51], v[200:203]
    ds_read_b128 a[16:19], v14 offset:8192
    v_mfma_f32_16x16x32_bf16 v[204:207], a[92:95], a[48:51], v[204:207]
    ds_read_b128 a[20:23], v14 offset:10240
    v_mfma_f32_16x16x32_bf16 v[208:211], a[80:83], a[52:55], v[208:211]
    s_add_u32 m0, s43, 53248
    v_mfma_f32_16x16x32_bf16 v[212:215], a[84:87], a[52:55], v[212:215]
    ds_read_b128 a[24:27], v14 offset:12288
    v_mfma_f32_16x16x32_bf16 v[216:219], a[88:91], a[52:55], v[216:219]
    ds_read_b128 a[28:31], v14 offset:14336
    v_mfma_f32_16x16x32_bf16 v[220:223], a[92:95], a[52:55], v[220:223]
    buffer_load_dwordx4 v4, s[8:11], s41 offen lds
    v_mfma_f32_16x16x32_bf16 v[224:227], a[80:83], a[56:59], v[224:227]
    v_mfma_f32_16x16x32_bf16 v[228:231], a[84:87], a[56:59], v[228:231]
    v_mfma_f32_16x16x32_bf16 v[232:235], a[88:91], a[56:59], v[232:235]
    buffer_load_dwordx4 v5, s[8:11], s41 offen offset:1024 lds
    v_mfma_f32_16x16x32_bf16 v[236:239], a[92:95], a[56:59], v[236:239]
    v_mfma_f32_16x16x32_bf16 v[240:243], a[80:83], a[60:63], v[240:243]
    v_mfma_f32_16x16x32_bf16 v[244:247], a[84:87], a[60:63], v[244:247]
    v_mfma_f32_16x16x32_bf16 v[248:251], a[88:91], a[60:63], v[248:251]
    v_mfma_f32_16x16x32_bf16 v[252:255], a[92:95], a[60:63], v[252:255]
    s_waitcnt lgkmcnt(0)
    v_mfma_f32_16x16x32_bf16 v[128:131], a[64:67], a[0:3], v[128:131]
    ds_read_b64_tr_b16 a[80:81], v20 offset:8192
    v_mfma_f32_16x16x32_bf16 v[132:135], a[68:71], a[0:3], v[132:135]
    ds_read_b64_tr_b16 a[82:83], v20 offset:8704
    v_mfma_f32_16x16x32_bf16 v[136:139], a[72:75], a[0:3], v[136:139]
    buffer_load_dwordx4 v6, s[8:11], s41 offen offset:2048 lds
    v_mfma_f32_16x16x32_bf16 v[140:143], a[76:79], a[0:3], v[140:143]
    ds_read_b64_tr_b16 a[84:85], v20 offset:10240
    v_mfma_f32_16x16x32_bf16 v[144:147], a[64:67], a[4:7], v[144:147]
    ds_read_b64_tr_b16 a[86:87], v20 offset:10752
    v_mfma_f32_16x16x32_bf16 v[148:151], a[68:71], a[4:7], v[148:151]
    buffer_load_dwordx4 v7, s[8:11], s41 offen offset:3072 lds
    v_mfma_f32_16x16x32_bf16 v[152:155], a[72:75], a[4:7], v[152:155]
    ds_read_b64_tr_b16 a[88:89], v21 offset:8192
    v_mfma_f32_16x16x32_bf16 v[156:159], a[76:79], a[4:7], v[156:159]
    ds_read_b64_tr_b16 a[90:91], v21 offset:8704
    v_mfma_f32_16x16x32_bf16 v[160:163], a[64:67], a[8:11], v[160:163]
    s_add_u32 s41, s41, 128
    v_mfma_f32_16x16x32_bf16 v[164:167], a[68:71], a[8:11], v[164:167]
    ds_read_b64_tr_b16 a[92:93], v21 offset:10240
    v_mfma_f32_16x16x32_bf16 v[168:171], a[72:75], a[8:11], v[168:171]
    ds_read_b64_tr_b16 a[94:95], v21 offset:10752
    v_mfma_f32_16x16x32_bf16 v[172:175], a[76:79], a[8:11], v[172:175]
    s_add_u32 m0, s44, 49152
    v_mfma_f32_16x16x32_bf16 v[176:179], a[64:67], a[12:15], v[176:179]
    ds_read_b128 a[32:35], v15 offset:0
    v_mfma_f32_16x16x32_bf16 v[180:183], a[68:71], a[12:15], v[180:183]
    ds_read_b128 a[36:39], v15 offset:2048
    v_mfma_f32_16x16x32_bf16 v[184:187], a[72:75], a[12:15], v[184:187]
    buffer_load_dwordx4 v8, s[12:15], s42 offen lds
    v_mfma_f32_16x16x32_bf16 v[188:191], a[76:79], a[12:15], v[188:191]
    ds_read_b128 a[40:43], v15 offset:4096
    v_mfma_f32_16x16x32_bf16 v[192:195], a[64:67], a[16:19], v[192:195]
    ds_read_b128 a[44:47], v15 offset:6144
    v_mfma_f32_16x16x32_bf16 v[196:199], a[68:71], a[16:19], v[196:199]
    buffer_load_dwordx4 v9, s[12:15], s42 offen offset:1024 lds
    v_mfma_f32_16x16x32_bf16 v[200:203], a[72:75], a[16:19], v[200:203]
    ds_read_b128 a[48:51], v15 offset:8192
    v_mfma_f32_16x16x32_bf16 v[204:207], a[76:79], a[16:19], v[204:207]
    ds_read_b128 a[52:55], v15 offset:10240
    v_mfma_f32_16x16x32_bf16 v[208:211], a[64:67], a[20:23], v[208:211]
    buffer_load_dwordx4 v8, s[16:19], s42 offen offset:2048 lds
    v_mfma_f32_16x16x32_bf16 v[212:215], a[68:71], a[20:23], v[212:215]
    ds_read_b128 a[56:59], v15 offset:12288
    v_mfma_f32_16x16x32_bf16 v[216:219], a[72:75], a[20:23], v[216:219]
    ds_read_b128 a[60:63], v15 offset:14336
    v_mfma_f32_16x16x32_bf16 v[220:223], a[76:79], a[20:23], v[220:223]
    buffer_load_dwordx4 v9, s[16:19], s42 offen offset:3072 lds
    v_mfma_f32_16x16x32_bf16 v[224:227], a[64:67], a[24:27], v[224:227]
    v_mfma_f32_16x16x32_bf16 v[228:231], a[68:71], a[24:27], v[228:231]
    v_mfma_f32_16x16x32_bf16 v[232:235], a[72:75], a[24:27], v[232:235]
    s_add_u32 s42, s42, 221184
    v_mfma_f32_16x16x32_bf16 v[236:239], a[76:79], a[24:27], v[236:239]
    v_mfma_f32_16x16x32_bf16 v[240:243], a[64:67], a[28:31], v[240:243]
    v_mfma_f32_16x16x32_bf16 v[244:247], a[68:71], a[28:31], v[244:247]
    v_mfma_f32_16x16x32_bf16 v[248:251], a[72:75], a[28:31], v[248:251]
    v_mfma_f32_16x16x32_bf16 v[252:255], a[76:79], a[28:31], v[252:255]
    s_waitcnt vmcnt(12) lgkmcnt(0)
    s_barrier
    v_mfma_f32_16x16x32_bf16 v[128:131], a[80:83], a[32:35], v[128:131]
    ds_read_b64_tr_b16 a[64:65], v16 offset:0
    v_mfma_f32_16x16x32_bf16 v[132:135], a[84:87], a[32:35], v[132:135]
    ds_read_b64_tr_b16 a[66:67], v16 offset:512
    v_mfma_f32_16x16x32_bf16 v[136:139], a[88:91], a[32:35], v[136:139]
    s_add_u32 m0, s43, 98304
    v_mfma_f32_16x16x32_bf16 v[140:143], a[92:95], a[32:35], v[140:143]
    ds_read_b64_tr_b16 a[68:69], v16 offset:2048
    v_mfma_f32_16x16x32_bf16 v[144:147], a[80:83], a[36:39], v[144:147]
    ds_read_b64_tr_b16 a[70:71], v16 offset:2560
    v_mfma_f32_16x16x32_bf16 v[148:151], a[84:87], a[36:39], v[148:151]
    buffer_load_dwordx4 v4, s[8:11], s40 offen lds
    v_mfma_f32_16x16x32_bf16 v[152:155], a[88:91], a[36:39], v[152:155]
    ds_read_b64_tr_b16 a[72:73], v17 offset:0
    v_mfma_f32_16x16x32_bf16 v[156:159], a[92:95], a[36:39], v[156:159]
    ds_read_b64_tr_b16 a[74:75], v17 offset:512
    v_mfma_f32_16x16x32_bf16 v[160:163], a[80:83], a[40:43], v[160:163]
    buffer_load_dwordx4 v5, s[8:11], s40 offen offset:1024 lds
    v_mfma_f32_16x16x32_bf16 v[164:167], a[84:87], a[40:43], v[164:167]
    ds_read_b64_tr_b16 a[76:77], v17 offset:2048
    v_mfma_f32_16x16x32_bf16 v[168:171], a[88:91], a[40:43], v[168:171]
    ds_read_b64_tr_b16 a[78:79], v17 offset:2560
    v_mfma_f32_16x16x32_bf16 v[172:175], a[92:95], a[40:43], v[172:175]
    buffer_load_dwordx4 v6, s[8:11], s40 offen offset:2048 lds
    v_mfma_f32_16x16x32_bf16 v[176:179], a[80:83], a[44:47], v[176:179]
    ds_read_b128 a[0:3], v10 offset:0
    v_mfma_f32_16x16x32_bf16 v[180:183], a[84:87], a[44:47], v[180:183]
    ds_read_b128 a[4:7], v10 offset:2048
    v_mfma_f32_16x16x32_bf16 v[184:187], a[88:91], a[44:47], v[184:187]
    buffer_load_dwordx4 v7, s[8:11], s40 offen offset:3072 lds
    v_mfma_f32_16x16x32_bf16 v[188:191], a[92:95], a[44:47], v[188:191]
    ds_read_b128 a[8:11], v10 offset:4096
    v_mfma_f32_16x16x32_bf16 v[192:195], a[80:83], a[48:51], v[192:195]
    ds_read_b128 a[12:15], v10 offset:6144
    v_mfma_f32_16x16x32_bf16 v[196:199], a[84:87], a[48:51], v[196:199]
    s_add_u32 s40, s40, 128
    v_mfma_f32_16x16x32_bf16 v[200:203], a[88:91], a[48:51], v[200:203]
    ds_read_b128 a[16:19], v10 offset:8192
    v_mfma_f32_16x16x32_bf16 v[204:207], a[92:95], a[48:51], v[204:207]
    ds_read_b128 a[20:23], v10 offset:10240
    v_mfma_f32_16x16x32_bf16 v[208:211], a[80:83], a[52:55], v[208:211]
    s_add_u32 m0, s43, 102400
    v_mfma_f32_16x16x32_bf16 v[212:215], a[84:87], a[52:55], v[212:215]
    ds_read_b128 a[24:27], v10 offset:12288
    v_mfma_f32_16x16x32_bf16 v[216:219], a[88:91], a[52:55], v[216:219]
    ds_read_b128 a[28:31], v10 offset:14336
    v_mfma_f32_16x16x32_bf16 v[220:223], a[92:95], a[52:55], v[220:223]
    buffer_load_dwordx4 v4, s[8:11], s41 offen lds
    v_mfma_f32_16x16x32_bf16 v[224:227], a[80:83], a[56:59], v[224:227]
    v_mfma_f32_16x16x32_bf16 v[228:231], a[84:87], a[56:59], v[228:231]
    v_mfma_f32_16x16x32_bf16 v[232:235], a[88:91], a[56:59], v[232:235]
    buffer_load_dwordx4 v5, s[8:11], s41 offen offset:1024 lds
    v_mfma_f32_16x16x32_bf16 v[236:239], a[92:95], a[56:59], v[236:239]
    v_mfma_f32_16x16x32_bf16 v[240:243], a[80:83], a[60:63], v[240:243]
    v_mfma_f32_16x16x32_bf16 v[244:247], a[84:87], a[60:63], v[244:247]
    v_mfma_f32_16x16x32_bf16 v[248:251], a[88:91], a[60:63], v[248:251]
    v_mfma_f32_16x16x32_bf16 v[252:255], a[92:95], a[60:63], v[252:255]
    s_waitcnt lgkmcnt(0)
    v_mfma_f32_16x16x32_bf16 v[128:131], a[64:67], a[0:3], v[128:131]
    ds_read_b64_tr_b16 a[80:81], v16 offset:8192
    v_mfma_f32_16x16x32_bf16 v[132:135], a[68:71], a[0:3], v[132:135]
    ds_read_b64_tr_b16 a[82:83], v16 offset:8704
    v_mfma_f32_16x16x32_bf16 v[136:139], a[72:75], a[0:3], v[136:139]
    buffer_load_dwordx4 v6, s[8:11], s41 offen offset:2048 lds
    v_mfma_f32_16x16x32_bf16 v[140:143], a[76:79], a[0:3], v[140:143]
    ds_read_b64_tr_b16 a[84:85], v16 offset:10240
    v_mfma_f32_16x16x32_bf16 v[144:147], a[64:67], a[4:7], v[144:147]
    ds_read_b64_tr_b16 a[86:87], v16 offset:10752
    v_mfma_f32_16x16x32_bf16 v[148:151], a[68:71], a[4:7], v[148:151]
    buffer_load_dwordx4 v7, s[8:11], s41 offen offset:3072 lds
    v_mfma_f32_16x16x32_bf16 v[152:155], a[72:75], a[4:7], v[152:155]
    ds_read_b64_tr_b16 a[88:89], v17 offset:8192
    v_mfma_f32_16x16x32_bf16 v[156:159], a[76:79], a[4:7], v[156:159]
    ds_read_b64_tr_b16 a[90:91], v17 offset:8704
    v_mfma_f32_16x16x32_bf16 v[160:163], a[64:67], a[8:11], v[160:163]
    s_add_u32 s41, s41, 128
    v_mfma_f32_16x16x32_bf16 v[164:167], a[68:71], a[8:11], v[164:167]
    ds_read_b64_tr_b16 a[92:93], v17 offset:10240
    v_mfma_f32_16x16x32_bf16 v[168:171], a[72:75], a[8:11], v[168:171]
    ds_read_b64_tr_b16 a[94:95], v17 offset:10752
    v_mfma_f32_16x16x32_bf16 v[172:175], a[76:79], a[8:11], v[172:175]
    s_add_u32 m0, s44, 98304
    v_mfma_f32_16x16x32_bf16 v[176:179], a[64:67], a[12:15], v[176:179]
    ds_read_b128 a[32:35], v11 offset:0
    v_mfma_f32_16x16x32_bf16 v[180:183], a[68:71], a[12:15], v[180:183]
    ds_read_b128 a[36:39], v11 offset:2048
    v_mfma_f32_16x16x32_bf16 v[184:187], a[72:75], a[12:15], v[184:187]
    buffer_load_dwordx4 v8, s[12:15], s42 offen lds
    v_mfma_f32_16x16x32_bf16 v[188:191], a[76:79], a[12:15], v[188:191]
    ds_read_b128 a[40:43], v11 offset:4096
    v_mfma_f32_16x16x32_bf16 v[192:195], a[64:67], a[16:19], v[192:195]
    ds_read_b128 a[44:47], v11 offset:6144
    v_mfma_f32_16x16x32_bf16 v[196:199], a[68:71], a[16:19], v[196:199]
    buffer_load_dwordx4 v9, s[12:15], s42 offen offset:1024 lds
    v_mfma_f32_16x16x32_bf16 v[200:203], a[72:75], a[16:19], v[200:203]
    ds_read_b128 a[48:51], v11 offset:8192
    v_mfma_f32_16x16x32_bf16 v[204:207], a[76:79], a[16:19], v[204:207]
    ds_read_b128 a[52:55], v11 offset:10240
    v_mfma_f32_16x16x32_bf16 v[208:211], a[64:67], a[20:23], v[208:211]
    buffer_load_dwordx4 v8, s[16:19], s42 offen offset:2048 lds
    v_mfma_f32_16x16x32_bf16 v[212:215], a[68:71], a[20:23], v[212:215]
    ds_read_b128 a[56:59], v11 offset:12288
    v_mfma_f32_16x16x32_bf16 v[216:219], a[72:75], a[20:23], v[216:219]
    ds_read_b128 a[60:63], v11 offset:14336
    v_mfma_f32_16x16x32_bf16 v[220:223], a[76:79], a[20:23], v[220:223]
    buffer_load_dwordx4 v9, s[16:19], s42 offen offset:3072 lds
    v_mfma_f32_16x16x32_bf16 v[224:227], a[64:67], a[24:27], v[224:227]
    v_mfma_f32_16x16x32_bf16 v[228:231], a[68:71], a[24:27], v[228:231]
    v_mfma_f32_16x16x32_bf16 v[232:235], a[72:75], a[24:27], v[232:235]
    s_add_u32 s42, s42, 221184
    v_mfma_f32_16x16x32_bf16 v[236:239], a[76:79], a[24:27], v[236:239]
    v_mfma_f32_16x16x32_bf16 v[240:243], a[64:67], a[28:31], v[240:243]
    v_mfma_f32_16x16x32_bf16 v[244:247], a[68:71], a[28:31], v[244:247]
    v_mfma_f32_16x16x32_bf16 v[248:251], a[72:75], a[28:31], v[248:251]
    v_mfma_f32_16x16x32_bf16 v[252:255], a[76:79], a[28:31], v[252:255]
    s_waitcnt vmcnt(12) lgkmcnt(0)
    s_barrier
    v_mfma_f32_16x16x32_bf16 v[128:131], a[80:83], a[32:35], v[128:131]
    ds_read_b64_tr_b16 a[64:65], v18 offset:0
    v_mfma_f32_16x16x32_bf16 v[132:135], a[84:87], a[32:35], v[132:135]
    ds_read_b64_tr_b16 a[66:67], v18 offset:512
    v_mfma_f32_16x16x32_bf16 v[136:139], a[88:91], a[32:35], v[136:139]
    s_add_u32 m0, s43, 0
    v_mfma_f32_16x16x32_bf16 v[140:143], a[92:95], a[32:35], v[140:143]
    ds_read_b64_tr_b16 a[68:69], v18 offset:2048
    v_mfma_f32_16x16x32_bf16 v[144:147], a[80:83], a[36:39], v[144:147]
    ds_read_b64_tr_b16 a[70:71], v18 offset:2560
    v_mfma_f32_16x16x32_bf16 v[148:151], a[84:87], a[36:39], v[148:151]
    buffer_load_dwordx4 v4, s[8:11], s40 offen lds
    v_mfma_f32_16x16x32_bf16 v[152:155], a[88:91], a[36:39], v[152:155]
    ds_read_b64_tr_b16 a[72:73], v19 offset:0
    v_mfma_f32_16x16x32_bf16 v[156:159], a[92:95], a[36:39], v[156:159]
    ds_read_b64_tr_b16 a[74:75], v19 offset:512
    v_mfma_f32_16x16x32_bf16 v[160:163], a[80:83], a[40:43], v[160:163]
    buffer_load_dwordx4 v5, s[8:11], s40 offen offset:1024 lds
    v_mfma_f32_16x16x32_bf16 v[164:167], a[84:87], a[40:43], v[164:167]
    ds_read_b64_tr_b16 a[76:77], v19 offset:2048
    v_mfma_f32_16x16x32_bf16 v[168:171], a[88:91], a[40:43], v[168:171]
    ds_read_b64_tr_b16 a[78:79], v19 offset:2560
    v_mfma_f32_16x16x32_bf16 v[172:175], a[92:95], a[40:43], v[172:175]
    buffer_load_dwordx4 v6, s[8:11], s40 offen offset:2048 lds
    v_mfma_f32_16x16x32_bf16 v[176:179], a[80:83], a[44:47], v[176:179]
    ds_read_b128 a[0:3], v12 offset:0
    v_mfma_f32_16x16x32_bf16 v[180:183], a[84:87], a[44:47], v[180:183]
    ds_read_b128 a[4:7], v12 offset:2048
    v_mfma_f32_16x16x32_bf16 v[184:187], a[88:91], a[44:47], v[184:187]
    buffer_load_dwordx4 v7, s[8:11], s40 offen offset:3072 lds
    v_mfma_f32_16x16x32_bf16 v[188:191], a[92:95], a[44:47], v[188:191]
    ds_read_b128 a[8:11], v12 offset:4096
    v_mfma_f32_16x16x32_bf16 v[192:195], a[80:83], a[48:51], v[192:195]
    ds_read_b128 a[12:15], v12 offset:6144
    v_mfma_f32_16x16x32_bf16 v[196:199], a[84:87], a[48:51], v[196:199]
    s_add_u32 s40, s40, 128
    v_mfma_f32_16x16x32_bf16 v[200:203], a[88:91], a[48:51], v[200:203]
    ds_read_b128 a[16:19], v12 offset:8192
    v_mfma_f32_16x16x32_bf16 v[204:207], a[92:95], a[48:51], v[204:207]
    ds_read_b128 a[20:23], v12 offset:10240
    v_mfma_f32_16x16x32_bf16 v[208:211], a[80:83], a[52:55], v[208:211]
    s_add_u32 m0, s43, 4096
    v_mfma_f32_16x16x32_bf16 v[212:215], a[84:87], a[52:55], v[212:215]
    ds_read_b128 a[24:27], v12 offset:12288
    v_mfma_f32_16x16x32_bf16 v[216:219], a[88:91], a[52:55], v[216:219]
    ds_read_b128 a[28:31], v12 offset:14336
    v_mfma_f32_16x16x32_bf16 v[220:223], a[92:95], a[52:55], v[220:223]
    buffer_load_dwordx4 v4, s[8:11], s41 offen lds
    v_mfma_f32_16x16x32_bf16 v[224:227], a[80:83], a[56:59], v[224:227]
    v_mfma_f32_16x16x32_bf16 v[228:231], a[84:87], a[56:59], v[228:231]
    v_mfma_f32_16x16x32_bf16 v[232:235], a[88:91], a[56:59], v[232:235]
    buffer_load_dwordx4 v5, s[8:11], s41 offen offset:1024 lds
    v_mfma_f32_16x16x32_bf16 v[236:239], a[92:95], a[56:59], v[236:239]
    v_mfma_f32_16x16x32_bf16 v[240:243], a[80:83], a[60:63], v[240:243]
    v_mfma_f32_16x16x32_bf16 v[244:247], a[84:87], a[60:63], v[244:247]
    v_mfma_f32_16x16x32_bf16 v[248:251], a[88:91], a[60:63], v[248:251]
    v_mfma_f32_16x16x32_bf16 v[252:255], a[92:95], a[60:63], v[252:255]
    s_waitcnt lgkmcnt(0)
    v_mfma_f32_16x16x32_bf16 v[128:131], a[64:67], a[0:3], v[128:131]
    ds_read_b64_tr_b16 a[80:81], v18 offset:8192
    v_mfma_f32_16x16x32_bf16 v[132:135], a[68:71], a[0:3], v[132:135]
    ds_read_b64_tr_b16 a[82:83], v18 offset:8704
    v_mfma_f32_16x16x32_bf16 v[136:139], a[72:75], a[0:3], v[136:139]
    buffer_load_dwordx4 v6, s[8:11], s41 offen offset:2048 lds
    v_mfma_f32_16x16x32_bf16 v[140:143], a[76:79], a[0:3], v[140:143]
    ds_read_b64_tr_b16 a[84:85], v18 offset:10240
    v_mfma_f32_16x16x32_bf16 v[144:147], a[64:67], a[4:7], v[144:147]
    ds_read_b64_tr_b16 a[86:87], v18 offset:10752
    v_mfma_f32_16x16x32_bf16 v[148:151], a[68:71], a[4:7], v[148:151]
    buffer_load_dwordx4 v7, s[8:11], s41 offen offset:3072 lds
    v_mfma_f32_16x16x32_bf16 v[152:155], a[72:75], a[4:7], v[152:155]
    ds_read_b64_tr_b16 a[88:89], v19 offset:8192
    v_mfma_f32_16x16x32_bf16 v[156:159], a[76:79], a[4:7], v[156:159]
    ds_read_b64_tr_b16 a[90:91], v19 offset:8704
    v_mfma_f32_16x16x32_bf16 v[160:163], a[64:67], a[8:11], v[160:163]
    s_add_u32 s41, s41, 128
    v_mfma_f32_16x16x32_bf16 v[164:167], a[68:71], a[8:11], v[164:167]
    ds_read_b64_tr_b16 a[92:93], v19 offset:10240
    v_mfma_f32_16x16x32_bf16 v[168:171], a[72:75], a[8:11], v[168:171]
    ds_read_b64_tr_b16 a[94:95], v19 offset:10752
    v_mfma_f32_16x16x32_bf16 v[172:175], a[76:79], a[8:11], v[172:175]
    s_add_u32 m0, s44, 0
    v_mfma_f32_16x16x32_bf16 v[176:179], a[64:67], a[12:15], v[176:179]
    ds_read_b128 a[32:35], v13 offset:0
    v_mfma_f32_16x16x32_bf16 v[180:183], a[68:71], a[12:15], v[180:183]
    ds_read_b128 a[36:39], v13 offset:2048
    v_mfma_f32_16x16x32_bf16 v[184:187], a[72:75], a[12:15], v[184:187]
    buffer_load_dwordx4 v8, s[12:15], s42 offen lds
    v_mfma_f32_16x16x32_bf16 v[188:191], a[76:79], a[12:15], v[188:191]
    ds_read_b128 a[40:43], v13 offset:4096
    v_mfma_f32_16x16x32_bf16 v[192:195], a[64:67], a[16:19], v[192:195]
    ds_read_b128 a[44:47], v13 offset:6144
    v_mfma_f32_16x16x32_bf16 v[196:199], a[68:71], a[16:19], v[196:199]
    buffer_load_dwordx4 v9, s[12:15], s42 offen offset:1024 lds
    v_mfma_f32_16x16x32_bf16 v[200:203], a[72:75], a[16:19], v[200:203]
    ds_read_b128 a[48:51], v13 offset:8192
    v_mfma_f32_16x16x32_bf16 v[204:207], a[76:79], a[16:19], v[204:207]
    ds_read_b128 a[52:55], v13 offset:10240
    v_mfma_f32_16x16x32_bf16 v[208:211], a[64:67], a[20:23], v[208:211]
    buffer_load_dwordx4 v8, s[16:19], s42 offen offset:2048 lds
    v_mfma_f32_16x16x32_bf16 v[212:215], a[68:71], a[20:23], v[212:215]
    ds_read_b128 a[56:59], v13 offset:12288
    v_mfma_f32_16x16x32_bf16 v[216:219], a[72:75], a[20:23], v[216:219]
    ds_read_b128 a[60:63], v13 offset:14336
    v_mfma_f32_16x16x32_bf16 v[220:223], a[76:79], a[20:23], v[220:223]
    buffer_load_dwordx4 v9, s[16:19], s42 offen offset:3072 lds
    v_mfma_f32_16x16x32_bf16 v[224:227], a[64:67], a[24:27], v[224:227]
    v_mfma_f32_16x16x32_bf16 v[228:231], a[68:71], a[24:27], v[228:231]
    v_mfma_f32_16x16x32_bf16 v[232:235], a[72:75], a[24:27], v[232:235]
    s_add_u32 s42, s42, 221184
    v_mfma_f32_16x16x32_bf16 v[236:239], a[76:79], a[24:27], v[236:239]
    v_mfma_f32_16x16x32_bf16 v[240:243], a[64:67], a[28:31], v[240:243]
    v_mfma_f32_16x16x32_bf16 v[244:247], a[68:71], a[28:31], v[244:247]
    v_mfma_f32_16x16x32_bf16 v[248:251], a[72:75], a[28:31], v[248:251]
    v_mfma_f32_16x16x32_bf16 v[252:255], a[76:79], a[28:31], v[252:255]
    s_waitcnt vmcnt(12) lgkmcnt(0)
    s_barrier
    v_mfma_f32_16x16x32_bf16 v[128:131], a[80:83], a[32:35], v[128:131]
    ds_read_b64_tr_b16 a[64:65], v20 offset:0
    v_mfma_f32_16x16x32_bf16 v[132:135], a[84:87], a[32:35], v[132:135]
    ds_read_b64_tr_b16 a[66:67], v20 offset:512
    v_mfma_f32_16x16x32_bf16 v[136:139], a[88:91], a[32:35], v[136:139]
    ds_read_b64_tr_b16 a[68:69], v20 offset:2048
    v_mov_b32 v2, 0
    v_mfma_f32_16x16x32_bf16 v[140:143], a[92:95], a[32:35], v[140:143]
    ds_read_b64_tr_b16 a[70:71], v20 offset:2560
    v_mfma_f32_16x16x32_bf16 v[144:147], a[80:83], a[36:39], v[144:147]
    ds_read_b64_tr_b16 a[72:73], v21 offset:0
    v_mfma_f32_16x16x32_bf16 v[148:151], a[84:87], a[36:39], v[148:151]
    s_mov_b32 s4, 12910720
    v_mfma_f32_16x16x32_bf16 v[152:155], a[88:91], a[36:39], v[152:155]
    ds_read_b64_tr_b16 a[74:75], v21 offset:512
    v_mfma_f32_16x16x32_bf16 v[156:159], a[92:95], a[36:39], v[156:159]
    ds_read_b64_tr_b16 a[76:77], v21 offset:2048
    v_mfma_f32_16x16x32_bf16 v[160:163], a[80:83], a[40:43], v[160:163]
    ds_read_b64_tr_b16 a[78:79], v21 offset:2560
    buffer_load_dword v124, v2, s[20:23], s4 offen sc1
    v_mfma_f32_16x16x32_bf16 v[164:167], a[84:87], a[40:43], v[164:167]
    ds_read_b128 a[0:3], v14 offset:0
    v_mfma_f32_16x16x32_bf16 v[168:171], a[88:91], a[40:43], v[168:171]
    ds_read_b128 a[4:7], v15 offset:0
    v_mfma_f32_16x16x32_bf16 v[172:175], a[92:95], a[40:43], v[172:175]
    v_cmp_eq_u32 s[92:93], 0, v1
    v_mfma_f32_16x16x32_bf16 v[176:179], a[80:83], a[44:47], v[176:179]
    ds_read_b128 a[8:11], v14 offset:2048
    v_mfma_f32_16x16x32_bf16 v[180:183], a[84:87], a[44:47], v[180:183]
    ds_read_b128 a[12:15], v15 offset:2048
    v_mfma_f32_16x16x32_bf16 v[184:187], a[88:91], a[44:47], v[184:187]
    ds_read_b64_tr_b16 a[16:17], v20 offset:8192
    v_mov_b32 v5, s45
    v_mfma_f32_16x16x32_bf16 v[188:191], a[92:95], a[44:47], v[188:191]
    ds_read_b64_tr_b16 a[18:19], v20 offset:8704
    v_mfma_f32_16x16x32_bf16 v[192:195], a[80:83], a[48:51], v[192:195]
    ds_read_b64_tr_b16 a[20:21], v20 offset:10240
    v_mfma_f32_16x16x32_bf16 v[196:199], a[84:87], a[48:51], v[196:199]
    v_mov_b32 v2, 0x7ffffff0
    v_mfma_f32_16x16x32_bf16 v[200:203], a[88:91], a[48:51], v[200:203]
    ds_read_b64_tr_b16 a[22:23], v20 offset:10752
    v_mfma_f32_16x16x32_bf16 v[204:207], a[92:95], a[48:51], v[204:207]
    ds_read_b64_tr_b16 a[24:25], v21 offset:8192
    v_mfma_f32_16x16x32_bf16 v[208:211], a[80:83], a[52:55], v[208:211]
    ds_read_b64_tr_b16 a[26:27], v21 offset:8704
    v_min_u32 v3, 13, v1
    v_mfma_f32_16x16x32_bf16 v[212:215], a[84:87], a[52:55], v[212:215]
    ds_read_b64_tr_b16 a[28:29], v21 offset:10240
    v_mfma_f32_16x16x32_bf16 v[216:219], a[88:91], a[52:55], v[216:219]
    ds_read_b64_tr_b16 a[30:31], v21 offset:10752
    v_mfma_f32_16x16x32_bf16 v[220:223], a[92:95], a[52:55], v[220:223]
    v_lshlrev_b32 v23, 8, v3
    v_mfma_f32_16x16x32_bf16 v[224:227], a[80:83], a[56:59], v[224:227]
    v_mfma_f32_16x16x32_bf16 v[228:231], a[84:87], a[56:59], v[228:231]
    v_mfma_f32_16x16x32_bf16 v[232:235], a[88:91], a[56:59], v[232:235]
    v_cndmask_b32 v4, v2, 0, s[92:93]
    v_mfma_f32_16x16x32_bf16 v[236:239], a[92:95], a[56:59], v[236:239]
    v_mfma_f32_16x16x32_bf16 v[240:243], a[80:83], a[60:63], v[240:243]
    v_mfma_f32_16x16x32_bf16 v[244:247], a[84:87], a[60:63], v[244:247]
    v_mfma_f32_16x16x32_bf16 v[248:251], a[88:91], a[60:63], v[248:251]
    v_mfma_f32_16x16x32_bf16 v[252:255], a[92:95], a[60:63], v[252:255]
    s_branch standalone__swiglu_ffn__prompt_kernel_pg3
.p2align 12
standalone__swiglu_ffn__prompt_kernel_stub3:
    s_setpc_b64 s[4:5]
standalone__swiglu_ffn__prompt_kernel_pg3:
    s_waitcnt vmcnt(0) lgkmcnt(0)
    s_barrier
    v_readfirstlane_b32 s4, v124
    s_nop 3
    s_cmp_eq_u32 s4, s45
    s_cbranch_scc1 standalone__swiglu_ffn__prompt_kernel_sa_fast
    s_mov_b32 s63, 0
standalone__swiglu_ffn__prompt_kernel_sa_p1:
    v_mov_b32 v2, 0
    s_mov_b32 s4, 12910720
    buffer_load_dword v124, v2, s[20:23], s4 offen sc1
    s_add_u32 s63, s63, 1
    s_waitcnt vmcnt(0)
    v_readfirstlane_b32 s4, v124
    s_cmp_ge_u32 s63, 60000
    s_cbranch_scc1 standalone__swiglu_ffn__prompt_kernel_sa_fast
    s_cmp_eq_u32 s4, s45
    s_cbranch_scc1 standalone__swiglu_ffn__prompt_kernel_sa_fast
    s_sleep 2
    s_branch standalone__swiglu_ffn__prompt_kernel_sa_p1
standalone__swiglu_ffn__prompt_kernel_sa_fast:
    s_cmp_ge_u32 s3, 2
    s_cbranch_scc1 standalone__swiglu_ffn__prompt_kernel_wd0skip_p1
    buffer_load_dwordx4 a[96:99], v22, s[20:23], s66 offen sc1
    buffer_load_dwordx4 a[100:103], v22, s[20:23], s66 offen offset:1024 sc1
    buffer_load_dwordx4 a[104:107], v22, s[20:23], s66 offen offset:2048 sc1
    buffer_load_dwordx4 a[108:111], v22, s[20:23], s66 offen offset:3072 sc1
    buffer_load_dwordx4 a[112:115], v125, s[20:23], s66 offen sc1
standalone__swiglu_ffn__prompt_kernel_wd0skip_p1:
    v_mfma_f32_16x16x32_bf16 v[128:131], a[64:67], a[0:3], v[128:131]
    ds_read_b64_tr_b16 a[80:81], v16 offset:0
    ds_read_b64_tr_b16 a[82:83], v16 offset:512
    buffer_load_dwordx4 a[116:119], v22, s[20:23], s60 offen sc1
    v_mfma_f32_16x16x32_bf16 v[132:135], a[68:71], a[0:3], v[132:135]
    ds_read_b64_tr_b16 a[84:85], v16 offset:2048
    ds_read_b64_tr_b16 a[86:87], v16 offset:2560
    v_mfma_f32_16x16x32_bf16 v[136:139], a[72:75], a[0:3], v[136:139]
    ds_read_b64_tr_b16 a[88:89], v17 offset:0
    ds_read_b64_tr_b16 a[90:91], v17 offset:512
    buffer_load_dwordx4 a[120:123], v22, s[20:23], s60 offen offset:1024 sc1
    v_mfma_f32_16x16x32_bf16 v[140:143], a[76:79], a[0:3], v[140:143]
    ds_read_b64_tr_b16 a[92:93], v17 offset:2048
    ds_read_b64_tr_b16 a[94:95], v17 offset:2560
    v_mfma_f32_16x16x32_bf16 v[128:131], a[16:19], a[4:7], v[128:131]
    ds_read_b128 a[48:51], v10 offset:0
    ds_read_b128 a[52:55], v11 offset:0
    v_mfma_f32_16x16x32_bf16 v[132:135], a[20:23], a[4:7], v[132:135]
    ds_read_b128 a[56:59], v10 offset:2048
    ds_read_b128 a[60:63], v11 offset:2048
    buffer_load_dwordx4 a[124:127], v22, s[20:23], s60 offen offset:2048 sc1
    v_mfma_f32_16x16x32_bf16 v[136:139], a[24:27], a[4:7], v[136:139]
    ds_read_b64_tr_b16 a[32:33], v16 offset:8192
    ds_read_b64_tr_b16 a[34:35], v16 offset:8704
    v_mfma_f32_16x16x32_bf16 v[140:143], a[28:31], a[4:7], v[140:143]
    ds_read_b64_tr_b16 a[36:37], v16 offset:10240
    ds_read_b64_tr_b16 a[38:39], v16 offset:10752
    buffer_load_dwordx4 a[128:131], v22, s[20:23], s60 offen offset:3072 sc1
    v_mfma_f32_16x16x32_bf16 v[144:147], a[64:67], a[8:11], v[144:147]
    ds_read_b64_tr_b16 a[40:41], v17 offset:8192
    ds_read_b64_tr_b16 a[42:43], v17 offset:8704
    v_mfma_f32_16x16x32_bf16 v[148:151], a[68:71], a[8:11], v[148:151]
    ds_read_b64_tr_b16 a[44:45], v17 offset:10240
    ds_read_b64_tr_b16 a[46:47], v17 offset:10752
    v_mfma_f32_16x16x32_bf16 v[152:155], a[72:75], a[8:11], v[152:155]
    buffer_load_dwordx4 a[132:135], v125, s[20:23], s60 offen sc1
    v_mfma_f32_16x16x32_bf16 v[156:159], a[76:79], a[8:11], v[156:159]
    v_mfma_f32_16x16x32_bf16 v[144:147], a[16:19], a[12:15], v[144:147]
    s_add_u32 s60, s60, 40960
    v_mfma_f32_16x16x32_bf16 v[148:151], a[20:23], a[12:15], v[148:151]
    v_mfma_f32_16x16x32_bf16 v[152:155], a[24:27], a[12:15], v[152:155]
    v_mfma_f32_16x16x32_bf16 v[156:159], a[28:31], a[12:15], v[156:159]
    s_waitcnt lgkmcnt(0)
    buffer_load_dwordx4 a[136:139], v22, s[20:23], s60 offen sc1
    v_mfma_f32_16x16x32_bf16 v[128:131], a[80:83], a[48:51], v[128:131]
    v_mfma_f32_16x16x32_bf16 v[132:135], a[84:87], a[48:51], v[132:135]
    ds_read_b128 a[0:3], v14 offset:4096
    buffer_load_dwordx4 a[140:143], v22, s[20:23], s60 offen offset:1024 sc1
    v_mfma_f32_16x16x32_bf16 v[136:139], a[88:91], a[48:51], v[136:139]
    v_mfma_f32_16x16x32_bf16 v[140:143], a[92:95], a[48:51], v[140:143]
    ds_read_b128 a[4:7], v15 offset:4096
    v_mfma_f32_16x16x32_bf16 v[128:131], a[32:35], a[52:55], v[128:131]
    buffer_load_dwordx4 a[144:147], v22, s[20:23], s60 offen offset:2048 sc1
    v_mfma_f32_16x16x32_bf16 v[132:135], a[36:39], a[52:55], v[132:135]
    ds_read_b128 a[8:11], v10 offset:4096
    v_mfma_f32_16x16x32_bf16 v[136:139], a[40:43], a[52:55], v[136:139]
    buffer_load_dwordx4 a[148:151], v22, s[20:23], s60 offen offset:3072 sc1
    v_mfma_f32_16x16x32_bf16 v[140:143], a[44:47], a[52:55], v[140:143]
    ds_read_b128 a[12:15], v11 offset:4096
    v_mfma_f32_16x16x32_bf16 v[144:147], a[80:83], a[56:59], v[144:147]
    v_mfma_f32_16x16x32_bf16 v[148:151], a[84:87], a[56:59], v[148:151]
    buffer_load_dwordx4 a[152:155], v125, s[20:23], s60 offen sc1
    v_mfma_f32_16x16x32_bf16 v[152:155], a[88:91], a[56:59], v[152:155]
    v_mfma_f32_16x16x32_bf16 v[156:159], a[92:95], a[56:59], v[156:159]
    v_mul_f32 v24, s46, v128
    v_mul_f32 v25, s46, v129
    v_mul_f32 v26, s46, v130
    v_mul_f32 v27, s46, v131
    v_mul_f32 v28, s46, v136
    s_add_u32 s60, s60, 40960
    v_mfma_f32_16x16x32_bf16 v[144:147], a[32:35], a[60:63], v[144:147]
    v_mul_f32 v29, s46, v137
    v_mul_f32 v30, s46, v138
    v_mul_f32 v31, s46, v139
    v_exp_f32 v24, v24
    v_mfma_f32_16x16x32_bf16 v[148:151], a[36:39], a[60:63], v[148:151]
    v_mul_f32 v32, v128, v132
    v_exp_f32 v25, v25
    v_mul_f32 v33, v129, v133
    v_exp_f32 v26, v26
    v_mfma_f32_16x16x32_bf16 v[152:155], a[40:43], a[60:63], v[152:155]
    v_mul_f32 v34, v130, v134
    v_exp_f32 v27, v27
    v_mul_f32 v35, v131, v135
    v_exp_f32 v28, v28
    buffer_load_dwordx4 a[156:159], v22, s[20:23], s60 offen sc1
    v_mfma_f32_16x16x32_bf16 v[156:159], a[44:47], a[60:63], v[156:159]
    s_waitcnt lgkmcnt(0)
    v_mul_f32 v36, v136, v140
    v_exp_f32 v29, v29
    v_mul_f32 v37, v137, v141
    v_exp_f32 v30, v30
    v_mfma_f32_16x16x32_bf16 v[160:163], a[64:67], a[0:3], v[160:163]
    v_mul_f32 v38, v138, v142
    v_exp_f32 v31, v31
    v_mul_f32 v39, v139, v143
    v_add_f32 v24, 1.0, v24
    buffer_load_dwordx4 a[160:163], v22, s[20:23], s60 offen offset:1024 sc1
    v_mfma_f32_16x16x32_bf16 v[164:167], a[68:71], a[0:3], v[164:167]
    ds_read_b128 a[48:51], v14 offset:6144
    v_add_f32 v25, 1.0, v25
    v_add_f32 v26, 1.0, v26
    v_add_f32 v27, 1.0, v27
    v_add_f32 v28, 1.0, v28
    v_add_f32 v29, 1.0, v29
    v_mfma_f32_16x16x32_bf16 v[168:171], a[72:75], a[0:3], v[168:171]
    v_add_f32 v30, 1.0, v30
    v_add_f32 v31, 1.0, v31
    v_rcp_f32 v24, v24
    v_rcp_f32 v25, v25
    v_mfma_f32_16x16x32_bf16 v[172:175], a[76:79], a[0:3], v[172:175]
    ds_read_b128 a[52:55], v15 offset:6144
    v_rcp_f32 v26, v26
    v_rcp_f32 v27, v27
    v_rcp_f32 v28, v28
    v_rcp_f32 v29, v29
    buffer_load_dwordx4 a[164:167], v22, s[20:23], s60 offen offset:2048 sc1
    v_mfma_f32_16x16x32_bf16 v[160:163], a[16:19], a[4:7], v[160:163]
    v_rcp_f32 v30, v30
    v_rcp_f32 v31, v31
    v_mul_f32 v32, v32, v24
    v_mul_f32 v33, v33, v25
    v_mfma_f32_16x16x32_bf16 v[164:167], a[20:23], a[4:7], v[164:167]
    ds_read_b128 a[56:59], v10 offset:6144
    v_mul_f32 v34, v34, v26
    v_mul_f32 v35, v35, v27
    v_mul_f32 v36, v36, v28
    v_mul_f32 v37, v37, v29
    buffer_load_dwordx4 a[168:171], v22, s[20:23], s60 offen offset:3072 sc1
    v_mfma_f32_16x16x32_bf16 v[168:171], a[24:27], a[4:7], v[168:171]
    v_mul_f32 v38, v38, v30
    v_mul_f32 v39, v39, v31
    v_cvt_pk_bf16_f32 v40, v32, v33
    v_cvt_pk_bf16_f32 v41, v34, v35
    v_mfma_f32_16x16x32_bf16 v[172:175], a[28:31], a[4:7], v[172:175]
    ds_read_b128 a[60:63], v11 offset:6144
    v_cvt_pk_bf16_f32 v42, v36, v37
    v_cvt_pk_bf16_f32 v43, v38, v39
    buffer_store_dwordx4 v[40:43], v22, s[20:23], s54 offen sc1
    s_add_u32 s54, s54, 55296
    v_mfma_f32_16x16x32_bf16 v[160:163], a[80:83], a[8:11], v[160:163]
    v_mul_f32 v44, s46, v144
    v_mul_f32 v45, s46, v145
    v_mul_f32 v46, s46, v146
    v_mul_f32 v47, s46, v147
    v_mul_f32 v48, s46, v152
    buffer_load_dwordx4 a[172:175], v125, s[20:23], s60 offen sc1
    v_mfma_f32_16x16x32_bf16 v[164:167], a[84:87], a[8:11], v[164:167]
    v_mul_f32 v49, s46, v153
    v_mul_f32 v50, s46, v154
    v_mul_f32 v51, s46, v155
    v_exp_f32 v44, v44
    v_mfma_f32_16x16x32_bf16 v[168:171], a[88:91], a[8:11], v[168:171]
    v_mul_f32 v52, v144, v148
    v_exp_f32 v45, v45
    v_mul_f32 v53, v145, v149
    v_exp_f32 v46, v46
    s_add_u32 s60, s60, 40960
    v_mfma_f32_16x16x32_bf16 v[172:175], a[92:95], a[8:11], v[172:175]
    v_mul_f32 v54, v146, v150
    v_exp_f32 v47, v47
    v_mul_f32 v55, v147, v151
    v_exp_f32 v48, v48
    v_mfma_f32_16x16x32_bf16 v[160:163], a[32:35], a[12:15], v[160:163]
    v_mul_f32 v56, v152, v156
    v_exp_f32 v49, v49
    v_mul_f32 v57, v153, v157
    v_exp_f32 v50, v50
    v_mfma_f32_16x16x32_bf16 v[164:167], a[36:39], a[12:15], v[164:167]
    v_mul_f32 v58, v154, v158
    v_exp_f32 v51, v51
    v_mul_f32 v59, v155, v159
    v_add_f32 v44, 1.0, v44
    buffer_load_dwordx4 a[176:179], v22, s[20:23], s60 offen sc1
    v_mfma_f32_16x16x32_bf16 v[168:171], a[40:43], a[12:15], v[168:171]
    v_add_f32 v45, 1.0, v45
    v_add_f32 v46, 1.0, v46
    v_add_f32 v47, 1.0, v47
    v_add_f32 v48, 1.0, v48
    v_add_f32 v49, 1.0, v49
    v_mfma_f32_16x16x32_bf16 v[172:175], a[44:47], a[12:15], v[172:175]
    s_waitcnt lgkmcnt(0)
    v_add_f32 v50, 1.0, v50
    v_add_f32 v51, 1.0, v51
    v_rcp_f32 v44, v44
    v_rcp_f32 v45, v45
    buffer_load_dwordx4 a[180:183], v22, s[20:23], s60 offen offset:1024 sc1
    v_mfma_f32_16x16x32_bf16 v[176:179], a[64:67], a[48:51], v[176:179]
    v_rcp_f32 v46, v46
    v_rcp_f32 v47, v47
    v_rcp_f32 v48, v48
    v_rcp_f32 v49, v49
    v_mfma_f32_16x16x32_bf16 v[180:183], a[68:71], a[48:51], v[180:183]
    ds_read_b128 a[0:3], v14 offset:8192
    v_rcp_f32 v50, v50
    v_rcp_f32 v51, v51
    v_mul_f32 v52, v52, v44
    v_mul_f32 v53, v53, v45
    v_mfma_f32_16x16x32_bf16 v[184:187], a[72:75], a[48:51], v[184:187]
    v_mul_f32 v54, v54, v46
    v_mul_f32 v55, v55, v47
    v_mul_f32 v56, v56, v48
    v_mul_f32 v57, v57, v49
    buffer_load_dwordx4 a[184:187], v22, s[20:23], s60 offen offset:2048 sc1
    v_mfma_f32_16x16x32_bf16 v[188:191], a[76:79], a[48:51], v[188:191]
    ds_read_b128 a[4:7], v15 offset:8192
    v_mul_f32 v58, v58, v50
    v_mul_f32 v59, v59, v51
    v_cvt_pk_bf16_f32 v60, v52, v53
    v_cvt_pk_bf16_f32 v61, v54, v55
    v_mfma_f32_16x16x32_bf16 v[176:179], a[16:19], a[52:55], v[176:179]
    v_cvt_pk_bf16_f32 v62, v56, v57
    v_cvt_pk_bf16_f32 v63, v58, v59
    buffer_store_dwordx4 v[60:63], v22, s[20:23], s54 offen sc1
    s_add_u32 s54, s54, 55296
    buffer_load_dwordx4 a[188:191], v22, s[20:23], s60 offen offset:3072 sc1
    v_mfma_f32_16x16x32_bf16 v[180:183], a[20:23], a[52:55], v[180:183]
    ds_read_b128 a[8:11], v10 offset:8192
    v_mul_f32 v24, s46, v160
    v_mul_f32 v25, s46, v161
    v_mul_f32 v26, s46, v162
    v_mul_f32 v27, s46, v163
    v_mul_f32 v28, s46, v168
    v_mfma_f32_16x16x32_bf16 v[184:187], a[24:27], a[52:55], v[184:187]
    v_mul_f32 v29, s46, v169
    v_mul_f32 v30, s46, v170
    v_mul_f32 v31, s46, v171
    v_exp_f32 v24, v24
    v_mfma_f32_16x16x32_bf16 v[188:191], a[28:31], a[52:55], v[188:191]
    ds_read_b128 a[12:15], v11 offset:8192
    v_mul_f32 v32, v160, v164
    v_exp_f32 v25, v25
    v_mul_f32 v33, v161, v165
    v_exp_f32 v26, v26
    buffer_load_dwordx4 a[192:195], v125, s[20:23], s60 offen sc1
    v_mfma_f32_16x16x32_bf16 v[176:179], a[80:83], a[56:59], v[176:179]
    v_mul_f32 v34, v162, v166
    v_exp_f32 v27, v27
    v_mul_f32 v35, v163, v167
    v_exp_f32 v28, v28
    v_mfma_f32_16x16x32_bf16 v[180:183], a[84:87], a[56:59], v[180:183]
    v_mul_f32 v36, v168, v172
    v_exp_f32 v29, v29
    v_mul_f32 v37, v169, v173
    v_exp_f32 v30, v30
    s_add_u32 s60, s60, 40960
    v_mfma_f32_16x16x32_bf16 v[184:187], a[88:91], a[56:59], v[184:187]
    v_mul_f32 v38, v170, v174
    v_exp_f32 v31, v31
    v_mul_f32 v39, v171, v175
    v_add_f32 v24, 1.0, v24
    v_mfma_f32_16x16x32_bf16 v[188:191], a[92:95], a[56:59], v[188:191]
    v_add_f32 v25, 1.0, v25
    v_add_f32 v26, 1.0, v26
    v_add_f32 v27, 1.0, v27
    v_add_f32 v28, 1.0, v28
    v_add_f32 v29, 1.0, v29
    v_mfma_f32_16x16x32_bf16 v[176:179], a[32:35], a[60:63], v[176:179]
    v_add_f32 v30, 1.0, v30
    v_add_f32 v31, 1.0, v31
    v_rcp_f32 v24, v24
    v_rcp_f32 v25, v25
    buffer_load_dwordx4 a[196:199], v22, s[20:23], s60 offen sc1
    v_mfma_f32_16x16x32_bf16 v[180:183], a[36:39], a[60:63], v[180:183]
    v_rcp_f32 v26, v26
    v_rcp_f32 v27, v27
    v_rcp_f32 v28, v28
    v_rcp_f32 v29, v29
    v_mfma_f32_16x16x32_bf16 v[184:187], a[40:43], a[60:63], v[184:187]
    v_rcp_f32 v30, v30
    v_rcp_f32 v31, v31
    v_mul_f32 v32, v32, v24
    v_mul_f32 v33, v33, v25
    buffer_load_dwordx4 a[200:203], v22, s[20:23], s60 offen offset:1024 sc1
    v_mfma_f32_16x16x32_bf16 v[188:191], a[44:47], a[60:63], v[188:191]
    s_waitcnt lgkmcnt(0)
    v_mul_f32 v34, v34, v26
    v_mul_f32 v35, v35, v27
    v_mul_f32 v36, v36, v28
    v_mul_f32 v37, v37, v29
    v_mfma_f32_16x16x32_bf16 v[192:195], a[64:67], a[0:3], v[192:195]
    v_mul_f32 v38, v38, v30
    v_mul_f32 v39, v39, v31
    v_cvt_pk_bf16_f32 v40, v32, v33
    v_cvt_pk_bf16_f32 v41, v34, v35
    v_mfma_f32_16x16x32_bf16 v[196:199], a[68:71], a[0:3], v[196:199]
    ds_read_b128 a[48:51], v14 offset:10240
    v_cvt_pk_bf16_f32 v42, v36, v37
    v_cvt_pk_bf16_f32 v43, v38, v39
    buffer_store_dwordx4 v[40:43], v22, s[20:23], s54 offen sc1
    s_add_u32 s54, s54, 55296
    buffer_load_dwordx4 a[204:207], v22, s[20:23], s60 offen offset:2048 sc1
    v_mfma_f32_16x16x32_bf16 v[200:203], a[72:75], a[0:3], v[200:203]
    v_mfma_f32_16x16x32_bf16 v[204:207], a[76:79], a[0:3], v[204:207]
    ds_read_b128 a[52:55], v15 offset:10240
    v_mul_f32 v44, s46, v176
    v_mul_f32 v45, s46, v177
    v_mul_f32 v46, s46, v178
    v_mul_f32 v47, s46, v179
    buffer_load_dwordx4 a[208:211], v22, s[20:23], s60 offen offset:3072 sc1
    v_mfma_f32_16x16x32_bf16 v[192:195], a[16:19], a[4:7], v[192:195]
    v_mul_f32 v48, s46, v184
    v_mul_f32 v49, s46, v185
    v_mul_f32 v50, s46, v186
    v_mul_f32 v51, s46, v187
    v_mfma_f32_16x16x32_bf16 v[196:199], a[20:23], a[4:7], v[196:199]
    ds_read_b128 a[56:59], v10 offset:10240
    v_exp_f32 v44, v44
    v_mul_f32 v52, v176, v180
    v_exp_f32 v45, v45
    v_mfma_f32_16x16x32_bf16 v[200:203], a[24:27], a[4:7], v[200:203]
    v_mul_f32 v53, v177, v181
    v_exp_f32 v46, v46
    v_mul_f32 v54, v178, v182
    v_exp_f32 v47, v47
    buffer_load_dwordx4 a[212:215], v125, s[20:23], s60 offen sc1
    v_mfma_f32_16x16x32_bf16 v[204:207], a[28:31], a[4:7], v[204:207]
    ds_read_b128 a[60:63], v11 offset:10240
    v_mul_f32 v55, v179, v183
    v_exp_f32 v48, v48
    v_mul_f32 v56, v184, v188
    v_mfma_f32_16x16x32_bf16 v[192:195], a[80:83], a[8:11], v[192:195]
    v_exp_f32 v49, v49
    v_mul_f32 v57, v185, v189
    v_exp_f32 v50, v50
    v_mul_f32 v58, v186, v190
    s_add_u32 s60, s60, 40960
    v_mfma_f32_16x16x32_bf16 v[196:199], a[84:87], a[8:11], v[196:199]
    v_exp_f32 v51, v51
    v_mul_f32 v59, v187, v191
    v_add_f32 v44, 1.0, v44
    v_add_f32 v45, 1.0, v45
    v_mfma_f32_16x16x32_bf16 v[200:203], a[88:91], a[8:11], v[200:203]
    v_add_f32 v46, 1.0, v46
    v_add_f32 v47, 1.0, v47
    v_add_f32 v48, 1.0, v48
    v_mfma_f32_16x16x32_bf16 v[204:207], a[92:95], a[8:11], v[204:207]
    v_add_f32 v49, 1.0, v49
    v_add_f32 v50, 1.0, v50
    v_add_f32 v51, 1.0, v51
    v_rcp_f32 v44, v44
    buffer_load_dwordx4 a[216:219], v22, s[20:23], s60 offen sc1
    v_mfma_f32_16x16x32_bf16 v[192:195], a[32:35], a[12:15], v[192:195]
    v_rcp_f32 v45, v45
    v_rcp_f32 v46, v46
    v_rcp_f32 v47, v47
    v_mfma_f32_16x16x32_bf16 v[196:199], a[36:39], a[12:15], v[196:199]
    v_rcp_f32 v48, v48
    v_rcp_f32 v49, v49
    v_rcp_f32 v50, v50
    v_rcp_f32 v51, v51
    buffer_load_dwordx4 a[220:223], v22, s[20:23], s60 offen offset:1024 sc1
    v_mfma_f32_16x16x32_bf16 v[200:203], a[40:43], a[12:15], v[200:203]
    v_mul_f32 v52, v52, v44
    v_mul_f32 v53, v53, v45
    v_mul_f32 v54, v54, v46
    v_mul_f32 v55, v55, v47
    v_mfma_f32_16x16x32_bf16 v[204:207], a[44:47], a[12:15], v[204:207]
    s_waitcnt lgkmcnt(0)
    v_mul_f32 v56, v56, v48
    v_mul_f32 v57, v57, v49
    v_mul_f32 v58, v58, v50
    v_mfma_f32_16x16x32_bf16 v[208:211], a[64:67], a[48:51], v[208:211]
    v_mul_f32 v59, v59, v51
    v_cvt_pk_bf16_f32 v60, v52, v53
    v_cvt_pk_bf16_f32 v61, v54, v55
    v_cvt_pk_bf16_f32 v62, v56, v57
    buffer_load_dwordx4 a[224:227], v22, s[20:23], s60 offen offset:2048 sc1
    v_mfma_f32_16x16x32_bf16 v[212:215], a[68:71], a[48:51], v[212:215]
    ds_read_b128 a[0:3], v14 offset:12288
    v_cvt_pk_bf16_f32 v63, v58, v59
    buffer_store_dwordx4 v[60:63], v22, s[20:23], s54 offen sc1
    s_add_u32 s54, s54, 55296
    v_mfma_f32_16x16x32_bf16 v[216:219], a[72:75], a[48:51], v[216:219]
    buffer_load_dwordx4 a[228:231], v22, s[20:23], s60 offen offset:3072 sc1
    v_mfma_f32_16x16x32_bf16 v[220:223], a[76:79], a[48:51], v[220:223]
    ds_read_b128 a[4:7], v15 offset:12288
    v_mul_f32 v24, s46, v192
    v_mul_f32 v25, s46, v193
    v_mul_f32 v26, s46, v194
    v_mul_f32 v27, s46, v195
    v_mfma_f32_16x16x32_bf16 v[208:211], a[16:19], a[52:55], v[208:211]
    v_mul_f32 v28, s46, v200
    v_mul_f32 v29, s46, v201
    v_mul_f32 v30, s46, v202
    v_mul_f32 v31, s46, v203
    v_mfma_f32_16x16x32_bf16 v[212:215], a[20:23], a[52:55], v[212:215]
    ds_read_b128 a[8:11], v10 offset:12288
    v_exp_f32 v24, v24
    v_mul_f32 v32, v192, v196
    v_exp_f32 v25, v25
    buffer_load_dwordx4 a[232:235], v125, s[20:23], s60 offen sc1
    v_mfma_f32_16x16x32_bf16 v[216:219], a[24:27], a[52:55], v[216:219]
    v_mul_f32 v33, v193, v197
    v_exp_f32 v26, v26
    v_mul_f32 v34, v194, v198
    v_exp_f32 v27, v27
    v_mfma_f32_16x16x32_bf16 v[220:223], a[28:31], a[52:55], v[220:223]
    ds_read_b128 a[12:15], v11 offset:12288
    v_mul_f32 v35, v195, v199
    v_exp_f32 v28, v28
    v_mul_f32 v36, v200, v204
    s_add_u32 s60, s60, 40960
    v_mfma_f32_16x16x32_bf16 v[208:211], a[80:83], a[56:59], v[208:211]
    v_exp_f32 v29, v29
    v_mul_f32 v37, v201, v205
    v_exp_f32 v30, v30
    v_mul_f32 v38, v202, v206
    v_mfma_f32_16x16x32_bf16 v[212:215], a[84:87], a[56:59], v[212:215]
    v_exp_f32 v31, v31
    v_mul_f32 v39, v203, v207
    v_add_f32 v24, 1.0, v24
    v_add_f32 v25, 1.0, v25
    v_mfma_f32_16x16x32_bf16 v[216:219], a[88:91], a[56:59], v[216:219]
    v_add_f32 v26, 1.0, v26
    v_add_f32 v27, 1.0, v27
    v_add_f32 v28, 1.0, v28
    buffer_load_dwordx4 a[236:239], v22, s[20:23], s60 offen sc1
    v_mfma_f32_16x16x32_bf16 v[220:223], a[92:95], a[56:59], v[220:223]
    v_add_f32 v29, 1.0, v29
    v_add_f32 v30, 1.0, v30
    v_add_f32 v31, 1.0, v31
    v_rcp_f32 v24, v24
    v_mfma_f32_16x16x32_bf16 v[208:211], a[32:35], a[60:63], v[208:211]
    v_rcp_f32 v25, v25
    v_rcp_f32 v26, v26
    v_rcp_f32 v27, v27
    buffer_load_dwordx4 a[240:243], v22, s[20:23], s60 offen offset:1024 sc1
    v_mfma_f32_16x16x32_bf16 v[212:215], a[36:39], a[60:63], v[212:215]
    v_rcp_f32 v28, v28
    v_rcp_f32 v29, v29
    v_rcp_f32 v30, v30
    v_rcp_f32 v31, v31
    v_mfma_f32_16x16x32_bf16 v[216:219], a[40:43], a[60:63], v[216:219]
    v_mul_f32 v32, v32, v24
    v_mul_f32 v33, v33, v25
    v_mul_f32 v34, v34, v26
    v_mul_f32 v35, v35, v27
    v_mfma_f32_16x16x32_bf16 v[220:223], a[44:47], a[60:63], v[220:223]
    s_waitcnt lgkmcnt(0)
    v_mul_f32 v36, v36, v28
    v_mul_f32 v37, v37, v29
    v_mul_f32 v38, v38, v30
    buffer_load_dwordx4 a[244:247], v22, s[20:23], s60 offen offset:2048 sc1
    v_mfma_f32_16x16x32_bf16 v[224:227], a[64:67], a[0:3], v[224:227]
    v_mul_f32 v39, v39, v31
    v_cvt_pk_bf16_f32 v40, v32, v33
    v_cvt_pk_bf16_f32 v41, v34, v35
    v_cvt_pk_bf16_f32 v42, v36, v37
    v_mfma_f32_16x16x32_bf16 v[228:231], a[68:71], a[0:3], v[228:231]
    ds_read_b128 a[48:51], v14 offset:14336
    v_cvt_pk_bf16_f32 v43, v38, v39
    buffer_store_dwordx4 v[40:43], v22, s[20:23], s54 offen sc1
    s_add_u32 s54, s54, 55296
    buffer_load_dwordx4 a[248:251], v22, s[20:23], s60 offen offset:3072 sc1
    v_mfma_f32_16x16x32_bf16 v[232:235], a[72:75], a[0:3], v[232:235]
    v_mfma_f32_16x16x32_bf16 v[236:239], a[76:79], a[0:3], v[236:239]
    ds_read_b128 a[52:55], v15 offset:14336
    v_mul_f32 v44, s46, v208
    v_mul_f32 v45, s46, v209
    v_mul_f32 v46, s46, v210
    v_mul_f32 v47, s46, v211
    v_mfma_f32_16x16x32_bf16 v[224:227], a[16:19], a[4:7], v[224:227]
    v_mul_f32 v48, s46, v216
    v_mul_f32 v49, s46, v217
    v_mul_f32 v50, s46, v218
    v_mul_f32 v51, s46, v219
    buffer_load_dwordx4 a[252:255], v125, s[20:23], s60 offen sc1
    v_mfma_f32_16x16x32_bf16 v[228:231], a[20:23], a[4:7], v[228:231]
    ds_read_b128 a[56:59], v10 offset:14336
    v_exp_f32 v44, v44
    v_mul_f32 v52, v208, v212
    v_exp_f32 v45, v45
    v_mfma_f32_16x16x32_bf16 v[232:235], a[24:27], a[4:7], v[232:235]
    v_mul_f32 v53, v209, v213
    v_exp_f32 v46, v46
    v_mul_f32 v54, v210, v214
    v_exp_f32 v47, v47
    s_add_u32 s60, s60, 40960
    v_mfma_f32_16x16x32_bf16 v[236:239], a[28:31], a[4:7], v[236:239]
    ds_read_b128 a[60:63], v11 offset:14336
    v_mul_f32 v55, v211, v215
    v_exp_f32 v48, v48
    v_mul_f32 v56, v216, v220
    v_mfma_f32_16x16x32_bf16 v[224:227], a[80:83], a[8:11], v[224:227]
    v_exp_f32 v49, v49
    v_mul_f32 v57, v217, v221
    v_exp_f32 v50, v50
    v_mul_f32 v58, v218, v222
    v_mfma_f32_16x16x32_bf16 v[228:231], a[84:87], a[8:11], v[228:231]
    v_exp_f32 v51, v51
    v_mul_f32 v59, v219, v223
    v_add_f32 v44, 1.0, v44
    v_add_f32 v45, 1.0, v45
    buffer_load_dwordx4 v[64:67], v22, s[20:23], s60 offen sc1
    v_mfma_f32_16x16x32_bf16 v[232:235], a[88:91], a[8:11], v[232:235]
    v_add_f32 v46, 1.0, v46
    v_add_f32 v47, 1.0, v47
    v_add_f32 v48, 1.0, v48
    v_mfma_f32_16x16x32_bf16 v[236:239], a[92:95], a[8:11], v[236:239]
    v_add_f32 v49, 1.0, v49
    v_add_f32 v50, 1.0, v50
    v_add_f32 v51, 1.0, v51
    v_rcp_f32 v44, v44
    buffer_load_dwordx4 v[68:71], v22, s[20:23], s60 offen offset:1024 sc1
    v_mfma_f32_16x16x32_bf16 v[224:227], a[32:35], a[12:15], v[224:227]
    v_rcp_f32 v45, v45
    v_rcp_f32 v46, v46
    v_rcp_f32 v47, v47
    v_mfma_f32_16x16x32_bf16 v[228:231], a[36:39], a[12:15], v[228:231]
    v_rcp_f32 v48, v48
    v_rcp_f32 v49, v49
    v_rcp_f32 v50, v50
    v_rcp_f32 v51, v51
    v_mfma_f32_16x16x32_bf16 v[232:235], a[40:43], a[12:15], v[232:235]
    v_mul_f32 v52, v52, v44
    v_mul_f32 v53, v53, v45
    v_mul_f32 v54, v54, v46
    v_mul_f32 v55, v55, v47
    buffer_load_dwordx4 v[72:75], v22, s[20:23], s60 offen offset:2048 sc1
    s_waitcnt vmcnt(11)
    buffer_store_dword v5, v4, s[20:23], s55 offen sc1
    v_mfma_f32_16x16x32_bf16 v[236:239], a[44:47], a[12:15], v[236:239]
    s_waitcnt lgkmcnt(0)
    v_mul_f32 v56, v56, v48
    v_mul_f32 v57, v57, v49
    v_mul_f32 v58, v58, v50
    v_mfma_f32_16x16x32_bf16 v[240:243], a[64:67], a[48:51], v[240:243]
    v_mul_f32 v59, v59, v51
    v_cvt_pk_bf16_f32 v60, v52, v53
    v_cvt_pk_bf16_f32 v61, v54, v55
    v_cvt_pk_bf16_f32 v62, v56, v57
    buffer_load_dwordx4 v[76:79], v22, s[20:23], s60 offen offset:3072 sc1
    v_mfma_f32_16x16x32_bf16 v[244:247], a[68:71], a[48:51], v[244:247]
    v_cvt_pk_bf16_f32 v63, v58, v59
    buffer_store_dwordx4 v[60:63], v22, s[20:23], s54 offen sc1
    s_add_u32 s54, s54, 55296
    v_mfma_f32_16x16x32_bf16 v[248:251], a[72:75], a[48:51], v[248:251]
    v_mfma_f32_16x16x32_bf16 v[252:255], a[76:79], a[48:51], v[252:255]
    v_mul_f32 v24, s46, v224
    v_mul_f32 v25, s46, v225
    v_mul_f32 v26, s46, v226
    v_mul_f32 v27, s46, v227
    v_mul_f32 v28, s46, v232
    buffer_load_dwordx4 v[80:83], v125, s[20:23], s60 offen sc1
    v_mfma_f32_16x16x32_bf16 v[240:243], a[16:19], a[52:55], v[240:243]
    v_mul_f32 v29, s46, v233
    v_mul_f32 v30, s46, v234
    v_mul_f32 v31, s46, v235
    v_exp_f32 v24, v24
    v_mfma_f32_16x16x32_bf16 v[244:247], a[20:23], a[52:55], v[244:247]
    v_mul_f32 v32, v224, v228
    v_exp_f32 v25, v25
    v_mul_f32 v33, v225, v229
    v_exp_f32 v26, v26
    s_add_u32 s60, s60, 40960
    v_mfma_f32_16x16x32_bf16 v[248:251], a[24:27], a[52:55], v[248:251]
    v_mul_f32 v34, v226, v230
    v_exp_f32 v27, v27
    v_mul_f32 v35, v227, v231
    v_exp_f32 v28, v28
    v_mfma_f32_16x16x32_bf16 v[252:255], a[28:31], a[52:55], v[252:255]
    v_mul_f32 v36, v232, v236
    v_exp_f32 v29, v29
    v_mul_f32 v37, v233, v237
    v_exp_f32 v30, v30
    v_mfma_f32_16x16x32_bf16 v[240:243], a[80:83], a[56:59], v[240:243]
    v_mul_f32 v38, v234, v238
    v_exp_f32 v31, v31
    v_mul_f32 v39, v235, v239
    v_add_f32 v24, 1.0, v24
    v_mfma_f32_16x16x32_bf16 v[244:247], a[84:87], a[56:59], v[244:247]
    v_add_f32 v25, 1.0, v25
    v_add_f32 v26, 1.0, v26
    v_add_f32 v27, 1.0, v27
    v_add_f32 v28, 1.0, v28
    v_add_f32 v29, 1.0, v29
    v_mfma_f32_16x16x32_bf16 v[248:251], a[88:91], a[56:59], v[248:251]
    v_add_f32 v30, 1.0, v30
    v_add_f32 v31, 1.0, v31
    v_rcp_f32 v24, v24
    v_rcp_f32 v25, v25
    v_mfma_f32_16x16x32_bf16 v[252:255], a[92:95], a[56:59], v[252:255]
    v_rcp_f32 v26, v26
    v_rcp_f32 v27, v27
    v_rcp_f32 v28, v28
    v_rcp_f32 v29, v29
    v_mfma_f32_16x16x32_bf16 v[240:243], a[32:35], a[60:63], v[240:243]
    v_rcp_f32 v30, v30
    v_rcp_f32 v31, v31
    v_mul_f32 v32, v32, v24
    v_mul_f32 v33, v33, v25
    v_mfma_f32_16x16x32_bf16 v[244:247], a[36:39], a[60:63], v[244:247]
    v_mul_f32 v34, v34, v26
    v_mul_f32 v35, v35, v27
    v_mul_f32 v36, v36, v28
    v_mul_f32 v37, v37, v29
    v_mfma_f32_16x16x32_bf16 v[248:251], a[40:43], a[60:63], v[248:251]
    v_mul_f32 v38, v38, v30
    v_mul_f32 v39, v39, v31
    v_cvt_pk_bf16_f32 v40, v32, v33
    v_cvt_pk_bf16_f32 v41, v34, v35
    v_mfma_f32_16x16x32_bf16 v[252:255], a[44:47], a[60:63], v[252:255]
    v_cvt_pk_bf16_f32 v42, v36, v37
    v_cvt_pk_bf16_f32 v43, v38, v39
    buffer_store_dwordx4 v[40:43], v22, s[20:23], s54 offen sc1
    s_add_u32 s54, s54, 55296
    s_branch standalone__swiglu_ffn__prompt_kernel_pg4
.p2align 12
standalone__swiglu_ffn__prompt_kernel_stub4:
    s_setpc_b64 s[4:5]
standalone__swiglu_ffn__prompt_kernel_pg4:
    s_barrier
    s_nop 2
    v_pk_mul_f32 v[44:45], v[240:241], s[46:47]
    buffer_load_dwordx4 v[84:87], v22, s[20:23], s60 offen sc1
    v_pk_mul_f32 v[46:47], v[242:243], s[46:47]
    v_pk_mul_f32 v[48:49], v[248:249], s[46:47]
    v_pk_mul_f32 v[50:51], v[250:251], s[46:47]
    v_exp_f32 v44, v44
    v_exp_f32 v45, v45
    v_pk_mul_f32 v[52:53], v[240:241], v[244:245]
    v_exp_f32 v46, v46
    v_exp_f32 v47, v47
    v_pk_mul_f32 v[54:55], v[242:243], v[246:247]
    buffer_load_dwordx4 v[88:91], v22, s[20:23], s60 offen offset:1024 sc1
    v_exp_f32 v48, v48
    v_exp_f32 v49, v49
    v_pk_mul_f32 v[56:57], v[248:249], v[252:253]
    v_exp_f32 v50, v50
    v_exp_f32 v51, v51
    v_pk_mul_f32 v[58:59], v[250:251], v[254:255]
    v_pk_add_f32 v[44:45], v[44:45], s[48:49]
    v_pk_add_f32 v[46:47], v[46:47], s[48:49]
    v_pk_add_f32 v[48:49], v[48:49], s[48:49]
    buffer_load_dwordx4 v[92:95], v22, s[20:23], s60 offen offset:2048 sc1
    v_pk_add_f32 v[50:51], v[50:51], s[48:49]
    v_rcp_f32 v44, v44
    v_rcp_f32 v45, v45
    v_rcp_f32 v46, v46
    v_rcp_f32 v47, v47
    v_rcp_f32 v48, v48
    v_rcp_f32 v49, v49
    v_rcp_f32 v50, v50
    v_rcp_f32 v51, v51
    buffer_load_dwordx4 v[96:99], v22, s[20:23], s60 offen offset:3072 sc1
    v_pk_mul_f32 v[52:53], v[52:53], v[44:45]
    v_pk_mul_f32 v[54:55], v[54:55], v[46:47]
    v_pk_mul_f32 v[56:57], v[56:57], v[48:49]
    v_pk_mul_f32 v[58:59], v[58:59], v[50:51]
    v_cvt_pk_bf16_f32 v60, v52, v53
    v_cvt_pk_bf16_f32 v61, v54, v55
    v_cvt_pk_bf16_f32 v62, v56, v57
    v_cvt_pk_bf16_f32 v63, v58, v59
    s_nop 0
    buffer_store_dwordx4 v[60:63], v22, s[20:23], s54 offen sc1
    s_add_u32 s54, s54, 55296
    buffer_load_dwordx4 v[100:103], v125, s[20:23], s60 offen sc1
    s_add_u32 s60, s60, 40960
    buffer_load_dwordx4 v[104:107], v22, s[20:23], s60 offen sc1
    buffer_load_dwordx4 v[108:111], v22, s[20:23], s60 offen offset:1024 sc1
    buffer_load_dwordx4 v[112:115], v22, s[20:23], s60 offen offset:2048 sc1
    buffer_load_dwordx4 v[116:119], v22, s[20:23], s60 offen offset:3072 sc1
    buffer_load_dwordx4 v[120:123], v125, s[20:23], s60 offen sc1
    s_add_u32 s60, s60, 40960
    buffer_load_dwordx4 a[0:3], v22, s[20:23], s60 offen sc1
    buffer_load_dwordx4 a[4:7], v22, s[20:23], s60 offen offset:1024 sc1
    buffer_load_dwordx4 a[8:11], v22, s[20:23], s60 offen offset:2048 sc1
    buffer_load_dwordx4 a[12:15], v22, s[20:23], s60 offen offset:3072 sc1
    s_waitcnt vmcnt(10)
    buffer_store_dword v5, v4, s[20:23], s55 offen offset:128 sc1
    buffer_load_dword v124, v23, s[20:23], s64 offen sc1
    buffer_load_dwordx4 a[16:19], v125, s[20:23], s60 offen sc1
    s_add_u32 s60, s60, 40960
    buffer_load_dwordx4 a[20:23], v22, s[20:23], s60 offen sc1
    buffer_load_dwordx4 a[24:27], v22, s[20:23], s60 offen offset:1024 sc1
    buffer_load_dwordx4 a[28:31], v22, s[20:23], s60 offen offset:2048 sc1
    buffer_load_dwordx4 a[32:35], v22, s[20:23], s60 offen offset:3072 sc1
    buffer_load_dwordx4 a[36:39], v125, s[20:23], s60 offen sc1
    s_add_u32 s60, s60, 40960
    buffer_load_dwordx4 a[40:43], v22, s[20:23], s60 offen sc1
    buffer_load_dwordx4 a[44:47], v22, s[20:23], s60 offen offset:1024 sc1
    buffer_load_dwordx4 a[48:51], v22, s[20:23], s60 offen offset:2048 sc1
    buffer_load_dwordx4 a[52:55], v22, s[20:23], s60 offen offset:3072 sc1
    buffer_load_dwordx4 a[56:59], v125, s[20:23], s60 offen sc1
    s_add_u32 s60, s60, 40960
    buffer_load_dword v21, v23, s[20:23], s64 offen sc1
    s_waitcnt vmcnt(12)
    v_cmp_ne_u32 vcc, s45, v124
    s_mov_b32 s6, 0
    s_nop 0
    s_cmp_eq_u64 vcc, 0
    s_cbranch_scc1 standalone__swiglu_ffn__prompt_kernel_polledE
    s_waitcnt vmcnt(0)
    v_cmp_ne_u32 vcc, s45, v21
    s_nop 1
    s_cmp_eq_u64 vcc, 0
    s_cbranch_scc1 standalone__swiglu_ffn__prompt_kernel_polledE
    s_branch standalone__swiglu_ffn__prompt_kernel_p2
standalone__swiglu_ffn__prompt_kernel_p0:
    s_mul_i32 s50, s36, 5
    s_add_u32 s50, s50, s37
    s_sub_u32 s69, s50, 27
    s_lshl_b32 s50, s69, 2
    s_add_u32 s50, s50, s3
standalone__swiglu_ffn__prompt_kernel_p0_nonon:
    s_lshl_b32 s68, s69, 2
    s_add_u32 s68, s68, s3
    s_sub_u32 s68, s68, 4
    s_max_i32 s68, s68, 0
    s_mul_i32 s51, s68, 14
    v_add_u32 v12, s51, v1
    v_min_u32 v12, 2047, v12
    v_mul_u32_u24 v12, 1280, v12
    v_add_u32 v12, 512, v12
    s_mul_i32 s51, s68, 12
    v_subrev_u32 v13, 14, v1
    v_subrev_u32 v14, 26, v1
    v_cmp_le_u32 vcc, 26, v1
    s_nop 1
    v_cndmask_b32 v13, v13, v14, vcc
    v_min_u32 v13, 11, v13
    v_add_u32 v13, s51, v13
    v_min_u32 v13, 1727, v13
    v_lshlrev_b32 v13, 7, v13
    v_add_u32 v13, 884736, v13
    v_mov_b32 v14, s12
    v_mov_b32 v15, s13
    s_add_u32 s51, s16, 2048
    s_addc_u32 s52, s17, 0
    v_mov_b32 v16, s51
    v_mov_b32 v17, s52
    v_cndmask_b32 v14, v14, v16, vcc
    v_cndmask_b32 v15, v15, v17, vcc
    v_cmp_gt_u32 vcc, 14, v1
    v_mov_b32 v16, s8
    v_mov_b32 v17, s9
    v_cndmask_b32 v14, v14, v16, vcc
    v_cndmask_b32 v15, v15, v17, vcc
    v_cndmask_b32 v13, v13, v12, vcc
    v_mov_b32 v12, 221184
    v_mov_b32 v18, 128
    v_cndmask_b32 v18, v12, v18, vcc
    v_add_co_u32 v16, vcc, v14, v13
    s_nop 1
    v_addc_co_u32 v17, vcc, 0, v15, vcc
    v_lshrrev_b32 v2, 4, v1
    v_and_b32 v3, 15, v1
    v_mul_u32_u24 v4, 1280, v2
    v_lshl_add_u32 v4, v3, 4, v4
    v_lshrrev_b32 v5, 2, v3
    v_and_b32 v6, 3, v3
    v_lshl_add_u32 v5, v2, 2, v5
    v_lshlrev_b32 v5, 8, v5
    v_lshl_add_u32 v5, v6, 3, v5
    s_mul_i32 s51, s3, 16384
    v_add_u32 v5, s51, v5
    s_cmp_lt_u32 s69, 30
    s_cselect_b32 s66, 3, 2
    s_cselect_b32 s67, 0, 30
    s_mul_i32 s68, s69, s66
    s_add_u32 s68, s68, s67
    s_add_u32 s68, s68, s3
    s_add_u32 s64, s68, 160
    s_cmp_lt_u32 s3, s66
    s_cselect_b32 s65, 1, 0
    s_mov_b32 s52, s50
    s_mul_i32 s53, s52, 52429
    s_lshr_b32 s53, s53, 18
    s_mul_i32 s66, s53, 5
    s_sub_u32 s66, s52, s66
    s_mul_i32 s67, s53, 40960
    s_lshl_b32 s68, s66, 8
    s_add_u32 s67, s67, s68
    s_mul_i32 s70, s53, 40960
    s_lshl_b32 s68, s66, 13
    s_add_u32 s70, s70, s68
    s_add_u32 s70, s70, 8388608
    s_add_u32 m0, s51, 0
    s_add_u32 s68, s67, 0
    buffer_load_dwordx4 v4, s[24:27], s68 offen nt lds
    s_add_u32 m0, s51, 1024
    s_add_u32 s68, s67, 5120
    buffer_load_dwordx4 v4, s[24:27], s68 offen nt lds
    s_add_u32 m0, s51, 2048
    s_add_u32 s68, s67, 10240
    buffer_load_dwordx4 v4, s[24:27], s68 offen nt lds
    s_add_u32 m0, s51, 3072
    s_add_u32 s68, s67, 15360
    buffer_load_dwordx4 v4, s[24:27], s68 offen nt lds
    s_add_u32 m0, s51, 4096
    s_add_u32 s68, s67, 20480
    buffer_load_dwordx4 v4, s[24:27], s68 offen nt lds
    s_add_u32 m0, s51, 5120
    s_add_u32 s68, s67, 25600
    buffer_load_dwordx4 v4, s[24:27], s68 offen nt lds
    s_add_u32 m0, s51, 6144
    s_add_u32 s68, s67, 30720
    buffer_load_dwordx4 v4, s[24:27], s68 offen nt lds
    s_add_u32 m0, s51, 7168
    s_add_u32 s68, s67, 35840
    buffer_load_dwordx4 v4, s[24:27], s68 offen nt lds
    s_cmp_eq_u32 s65, 0
    s_cbranch_scc1 standalone__swiglu_ffn__prompt_kernel_p0_ld_done
    s_mov_b32 s52, s64
    s_mul_i32 s53, s52, 52429
    s_lshr_b32 s53, s53, 18
    s_mul_i32 s66, s53, 5
    s_sub_u32 s66, s52, s66
    s_mul_i32 s67, s53, 40960
    s_lshl_b32 s68, s66, 8
    s_add_u32 s67, s67, s68
    s_mul_i32 s71, s53, 40960
    s_lshl_b32 s68, s66, 13
    s_add_u32 s71, s71, s68
    s_add_u32 s71, s71, 8388608
    s_add_u32 m0, s51, 8192
    s_add_u32 s68, s67, 0
    buffer_load_dwordx4 v4, s[24:27], s68 offen nt lds
    s_add_u32 m0, s51, 9216
    s_add_u32 s68, s67, 5120
    buffer_load_dwordx4 v4, s[24:27], s68 offen nt lds
    s_add_u32 m0, s51, 10240
    s_add_u32 s68, s67, 10240
    buffer_load_dwordx4 v4, s[24:27], s68 offen nt lds
    s_add_u32 m0, s51, 11264
    s_add_u32 s68, s67, 15360
    buffer_load_dwordx4 v4, s[24:27], s68 offen nt lds
    s_add_u32 m0, s51, 12288
    s_add_u32 s68, s67, 20480
    buffer_load_dwordx4 v4, s[24:27], s68 offen nt lds
    s_add_u32 m0, s51, 13312
    s_add_u32 s68, s67, 25600
    buffer_load_dwordx4 v4, s[24:27], s68 offen nt lds
    s_add_u32 m0, s51, 14336
    s_add_u32 s68, s67, 30720
    buffer_load_dwordx4 v4, s[24:27], s68 offen nt lds
    s_add_u32 m0, s51, 15360
    s_add_u32 s68, s67, 35840
    buffer_load_dwordx4 v4, s[24:27], s68 offen nt lds
standalone__swiglu_ffn__prompt_kernel_p0_ld_done:
    s_getpc_b64 s[66:67]
standalone__swiglu_ffn__prompt_kernel_pcref:
    s_sub_u32 s66, s66, standalone__swiglu_ffn__prompt_kernel_pcref-standalone__swiglu_ffn__prompt_kernel
    s_subb_u32 s67, s67, 0
    s_lshl_b32 s68, s3, 10
    v_add_u32 v6, s68, v22
    v_add_u32 v4, 0, v6
    v_min_u32 v4, standalone__swiglu_ffn__prompt_kernel_codeend-standalone__swiglu_ffn__prompt_kernel-16, v4
    v_mov_b32 v3, s67
    v_add_co_u32 v2, vcc, s66, v4
    s_nop 1
    v_addc_co_u32 v3, vcc, 0, v3, vcc
    global_load_dwordx4 v[24:27], v[2:3], off
    v_add_u32 v4, 4096, v6
    v_min_u32 v4, standalone__swiglu_ffn__prompt_kernel_codeend-standalone__swiglu_ffn__prompt_kernel-16, v4
    v_mov_b32 v3, s67
    v_add_co_u32 v2, vcc, s66, v4
    s_nop 1
    v_addc_co_u32 v3, vcc, 0, v3, vcc
    global_load_dwordx4 v[28:31], v[2:3], off
    v_add_u32 v4, 8192, v6
    v_min_u32 v4, standalone__swiglu_ffn__prompt_kernel_codeend-standalone__swiglu_ffn__prompt_kernel-16, v4
    v_mov_b32 v3, s67
    v_add_co_u32 v2, vcc, s66, v4
    s_nop 1
    v_addc_co_u32 v3, vcc, 0, v3, vcc
    global_load_dwordx4 v[32:35], v[2:3], off
    v_add_u32 v4, 12288, v6
    v_min_u32 v4, standalone__swiglu_ffn__prompt_kernel_codeend-standalone__swiglu_ffn__prompt_kernel-16, v4
    v_mov_b32 v3, s67
    v_add_co_u32 v2, vcc, s66, v4
    s_nop 1
    v_addc_co_u32 v3, vcc, 0, v3, vcc
    global_load_dwordx4 v[36:39], v[2:3], off
    v_add_u32 v4, 16384, v6
    v_min_u32 v4, standalone__swiglu_ffn__prompt_kernel_codeend-standalone__swiglu_ffn__prompt_kernel-16, v4
    v_mov_b32 v3, s67
    v_add_co_u32 v2, vcc, s66, v4
    s_nop 1
    v_addc_co_u32 v3, vcc, 0, v3, vcc
    global_load_dwordx4 v[24:27], v[2:3], off
    v_add_u32 v4, 20480, v6
    v_min_u32 v4, standalone__swiglu_ffn__prompt_kernel_codeend-standalone__swiglu_ffn__prompt_kernel-16, v4
    v_mov_b32 v3, s67
    v_add_co_u32 v2, vcc, s66, v4
    s_nop 1
    v_addc_co_u32 v3, vcc, 0, v3, vcc
    global_load_dwordx4 v[28:31], v[2:3], off
    v_add_u32 v4, 24576, v6
    v_min_u32 v4, standalone__swiglu_ffn__prompt_kernel_codeend-standalone__swiglu_ffn__prompt_kernel-16, v4
    v_mov_b32 v3, s67
    v_add_co_u32 v2, vcc, s66, v4
    s_nop 1
    v_addc_co_u32 v3, vcc, 0, v3, vcc
    global_load_dwordx4 v[32:35], v[2:3], off
    v_add_u32 v4, 28672, v6
    v_min_u32 v4, standalone__swiglu_ffn__prompt_kernel_codeend-standalone__swiglu_ffn__prompt_kernel-16, v4
    v_mov_b32 v3, s67
    v_add_co_u32 v2, vcc, s66, v4
    s_nop 1
    v_addc_co_u32 v3, vcc, 0, v3, vcc
    global_load_dwordx4 v[36:39], v[2:3], off
    v_add_u32 v4, 32768, v6
    v_min_u32 v4, standalone__swiglu_ffn__prompt_kernel_codeend-standalone__swiglu_ffn__prompt_kernel-16, v4
    v_mov_b32 v3, s67
    v_add_co_u32 v2, vcc, s66, v4
    s_nop 1
    v_addc_co_u32 v3, vcc, 0, v3, vcc
    global_load_dwordx4 v[24:27], v[2:3], off
    s_cmp_eq_u32 s65, 0
    s_cbranch_scc1 standalone__swiglu_ffn__prompt_kernel_p0_one
    s_waitcnt vmcnt(17)
    v_readfirstlane_b32 s45, v61
    s_nop 3
    s_add_u32 s45, s45, 1
    s_or_b32 s45, s45, 0x80000000
    s_cmp_lg_u32 s3, 0
    s_cbranch_scc1 standalone__swiglu_ffn__prompt_kernel_st_p0a
    s_lshl_b32 s4, s2, 2
    s_add_u32 s4, s4, 12914688
    v_mov_b32 v2, 0
    v_mov_b32 v3, s45
    s_mov_b64 exec, 1
    buffer_store_dword v3, v2, s[20:23], s4 offen sc1
    s_mov_b64 exec, -1
standalone__swiglu_ffn__prompt_kernel_st_p0a:
    ds_read_b64_tr_b16 v[56:57], v5 offset:0
    ds_read_b64_tr_b16 v[58:59], v5 offset:4096
    ds_read_b64_tr_b16 v[60:61], v5 offset:32
    ds_read_b64_tr_b16 v[62:63], v5 offset:4128
    ds_read_b64_tr_b16 v[64:65], v5 offset:64
    ds_read_b64_tr_b16 v[66:67], v5 offset:4160
    ds_read_b64_tr_b16 v[68:69], v5 offset:96
    ds_read_b64_tr_b16 v[70:71], v5 offset:4192
    ds_read_b64_tr_b16 v[72:73], v5 offset:128
    ds_read_b64_tr_b16 v[74:75], v5 offset:4224
    ds_read_b64_tr_b16 v[76:77], v5 offset:160
    ds_read_b64_tr_b16 v[78:79], v5 offset:4256
    ds_read_b64_tr_b16 v[80:81], v5 offset:192
    ds_read_b64_tr_b16 v[82:83], v5 offset:4288
    ds_read_b64_tr_b16 v[84:85], v5 offset:224
    ds_read_b64_tr_b16 v[86:87], v5 offset:4320
    s_waitcnt lgkmcnt(0)
    s_add_u32 s68, s70, 0
    buffer_store_dwordx4 v[56:59], v22, s[20:23], s68 offen sc1
    s_add_u32 s68, s70, 1024
    buffer_store_dwordx4 v[60:63], v22, s[20:23], s68 offen sc1
    s_add_u32 s68, s70, 2048
    buffer_store_dwordx4 v[64:67], v22, s[20:23], s68 offen sc1
    s_add_u32 s68, s70, 3072
    buffer_store_dwordx4 v[68:71], v22, s[20:23], s68 offen sc1
    s_add_u32 s68, s70, 4096
    buffer_store_dwordx4 v[72:75], v22, s[20:23], s68 offen sc1
    s_add_u32 s68, s70, 5120
    buffer_store_dwordx4 v[76:79], v22, s[20:23], s68 offen sc1
    s_add_u32 s68, s70, 6144
    buffer_store_dwordx4 v[80:83], v22, s[20:23], s68 offen sc1
    s_add_u32 s68, s70, 7168
    buffer_store_dwordx4 v[84:87], v22, s[20:23], s68 offen sc1
    s_waitcnt vmcnt(17)
    ds_read_b64_tr_b16 v[88:89], v5 offset:8192
    ds_read_b64_tr_b16 v[90:91], v5 offset:12288
    ds_read_b64_tr_b16 v[92:93], v5 offset:8224
    ds_read_b64_tr_b16 v[94:95], v5 offset:12320
    ds_read_b64_tr_b16 v[96:97], v5 offset:8256
    ds_read_b64_tr_b16 v[98:99], v5 offset:12352
    ds_read_b64_tr_b16 v[100:101], v5 offset:8288
    ds_read_b64_tr_b16 v[102:103], v5 offset:12384
    ds_read_b64_tr_b16 v[104:105], v5 offset:8320
    ds_read_b64_tr_b16 v[106:107], v5 offset:12416
    ds_read_b64_tr_b16 v[108:109], v5 offset:8352
    ds_read_b64_tr_b16 v[110:111], v5 offset:12448
    ds_read_b64_tr_b16 v[112:113], v5 offset:8384
    ds_read_b64_tr_b16 v[114:115], v5 offset:12480
    ds_read_b64_tr_b16 v[116:117], v5 offset:8416
    ds_read_b64_tr_b16 v[118:119], v5 offset:12512
    s_waitcnt lgkmcnt(0)
    s_add_u32 s68, s71, 0
    buffer_store_dwordx4 v[88:91], v22, s[20:23], s68 offen sc1
    s_add_u32 s68, s71, 1024
    buffer_store_dwordx4 v[92:95], v22, s[20:23], s68 offen sc1
    s_add_u32 s68, s71, 2048
    buffer_store_dwordx4 v[96:99], v22, s[20:23], s68 offen sc1
    s_add_u32 s68, s71, 3072
    buffer_store_dwordx4 v[100:103], v22, s[20:23], s68 offen sc1
    s_add_u32 s68, s71, 4096
    buffer_store_dwordx4 v[104:107], v22, s[20:23], s68 offen sc1
    s_add_u32 s68, s71, 5120
    buffer_store_dwordx4 v[108:111], v22, s[20:23], s68 offen sc1
    s_add_u32 s68, s71, 6144
    buffer_store_dwordx4 v[112:115], v22, s[20:23], s68 offen sc1
    s_add_u32 s68, s71, 7168
    buffer_store_dwordx4 v[116:119], v22, s[20:23], s68 offen sc1
    s_branch standalone__swiglu_ffn__prompt_kernel_p0_done
standalone__swiglu_ffn__prompt_kernel_p0_one:
    s_waitcnt vmcnt(9)
    v_readfirstlane_b32 s45, v61
    s_nop 3
    s_add_u32 s45, s45, 1
    s_or_b32 s45, s45, 0x80000000
    s_cmp_lg_u32 s3, 0
    s_cbranch_scc1 standalone__swiglu_ffn__prompt_kernel_st_p0b
    s_lshl_b32 s4, s2, 2
    s_add_u32 s4, s4, 12914688
    v_mov_b32 v2, 0
    v_mov_b32 v3, s45
    s_mov_b64 exec, 1
    buffer_store_dword v3, v2, s[20:23], s4 offen sc1
    s_mov_b64 exec, -1
standalone__swiglu_ffn__prompt_kernel_st_p0b:
    ds_read_b64_tr_b16 v[56:57], v5 offset:0
    ds_read_b64_tr_b16 v[58:59], v5 offset:4096
    ds_read_b64_tr_b16 v[60:61], v5 offset:32
    ds_read_b64_tr_b16 v[62:63], v5 offset:4128
    ds_read_b64_tr_b16 v[64:65], v5 offset:64
    ds_read_b64_tr_b16 v[66:67], v5 offset:4160
    ds_read_b64_tr_b16 v[68:69], v5 offset:96
    ds_read_b64_tr_b16 v[70:71], v5 offset:4192
    ds_read_b64_tr_b16 v[72:73], v5 offset:128
    ds_read_b64_tr_b16 v[74:75], v5 offset:4224
    ds_read_b64_tr_b16 v[76:77], v5 offset:160
    ds_read_b64_tr_b16 v[78:79], v5 offset:4256
    ds_read_b64_tr_b16 v[80:81], v5 offset:192
    ds_read_b64_tr_b16 v[82:83], v5 offset:4288
    ds_read_b64_tr_b16 v[84:85], v5 offset:224
    ds_read_b64_tr_b16 v[86:87], v5 offset:4320
    s_waitcnt lgkmcnt(0)
    s_add_u32 s68, s70, 0
    buffer_store_dwordx4 v[56:59], v22, s[20:23], s68 offen sc1
    s_add_u32 s68, s70, 1024
    buffer_store_dwordx4 v[60:63], v22, s[20:23], s68 offen sc1
    s_add_u32 s68, s70, 2048
    buffer_store_dwordx4 v[64:67], v22, s[20:23], s68 offen sc1
    s_add_u32 s68, s70, 3072
    buffer_store_dwordx4 v[68:71], v22, s[20:23], s68 offen sc1
    s_add_u32 s68, s70, 4096
    buffer_store_dwordx4 v[72:75], v22, s[20:23], s68 offen sc1
    s_add_u32 s68, s70, 5120
    buffer_store_dwordx4 v[76:79], v22, s[20:23], s68 offen sc1
    s_add_u32 s68, s70, 6144
    buffer_store_dwordx4 v[80:83], v22, s[20:23], s68 offen sc1
    s_add_u32 s68, s70, 7168
    buffer_store_dwordx4 v[84:87], v22, s[20:23], s68 offen sc1
standalone__swiglu_ffn__prompt_kernel_p0_done:
standalone__swiglu_ffn__prompt_kernel_p0_w:
    s_waitcnt vmcnt(0)
    s_barrier
    s_cmp_lg_u32 s3, 0
    s_cbranch_scc1 standalone__swiglu_ffn__prompt_kernel_p0_sig
    s_lshl_b32 s68, s69, 7
    s_add_u32 s68, s68, 12845056
    v_mov_b32 v2, 0
    v_mov_b32 v3, s45
    s_mov_b64 exec, 1
    buffer_store_dword v3, v2, s[20:23], s68 offen sc1
    s_mov_b64 exec, -1
standalone__swiglu_ffn__prompt_kernel_p0_sig:
    s_cmp_eq_u32 s2, 216
    s_cbranch_scc1 standalone__swiglu_ffn__prompt_kernel_p0_notouch
    global_load_dword v40, v[16:17], off
    v_add_co_u32 v16, vcc, v16, v18
    s_nop 1
    v_addc_co_u32 v17, vcc, 0, v17, vcc
    global_load_dword v40, v[16:17], off
    v_add_co_u32 v16, vcc, v16, v18
    s_nop 1
    v_addc_co_u32 v17, vcc, 0, v17, vcc
    global_load_dword v40, v[16:17], off
    v_add_co_u32 v16, vcc, v16, v18
    s_nop 1
    v_addc_co_u32 v17, vcc, 0, v17, vcc
    global_load_dword v40, v[16:17], off
    v_add_co_u32 v16, vcc, v16, v18
    s_nop 1
    v_addc_co_u32 v17, vcc, 0, v17, vcc
    global_load_dword v40, v[16:17], off
    v_add_co_u32 v16, vcc, v16, v18
    s_nop 1
    v_addc_co_u32 v17, vcc, 0, v17, vcc
    global_load_dword v40, v[16:17], off
    v_add_co_u32 v16, vcc, v16, v18
    s_nop 1
    v_addc_co_u32 v17, vcc, 0, v17, vcc
standalone__swiglu_ffn__prompt_kernel_p0_notouch:
    s_lshr_b32 s50, s37, 2
    s_lshr_b32 s51, s36, 1
    s_lshl_b32 s51, s51, 3
    s_add_u32 s61, s50, s51
    s_and_b32 s62, s37, 3
    s_and_b32 s51, s36, 1
    s_lshl_b32 s51, s51, 2
    s_add_u32 s62, s62, s51
    s_mul_i32 s52, s3, 14
    s_sub_u32 s53, s3, 1
    s_cmp_ge_u32 s3, 2
    s_cselect_b32 s53, s53, 0
    s_sub_u32 s52, s52, s53
    s_mul_i32 s60, s52, 40
    s_mul_i32 s53, s62, 5
    s_add_u32 s60, s60, s53
    s_lshl_b32 s60, s60, 10
    s_add_u32 s66, s60, 8388608
    s_add_u32 s60, s66, 40960
    s_lshr_b32 s53, s61, 1
    s_lshl_b32 s53, s53, 6
    s_add_u32 s53, s53, s52
    s_lshl_b32 s64, s53, 8
    s_add_u32 s64, s64, 12582912
    s_lshr_b32 s50, s61, 1
    s_lshl_b32 s50, s50, 3
    s_and_b32 s51, s61, 1
    s_lshl_b32 s51, s51, 1
    s_add_u32 s50, s50, s51
    s_cmp_eq_u32 s3, 2
    s_cselect_b32 s53, 1, 0
    s_add_u32 s53, s53, s50
    s_mul_i32 s53, s53, 54
    s_add_u32 s53, s53, s52
    s_lshl_b32 s53, s53, 10
    s_add_u32 s56, s53, 0
    s_cmp_eq_u32 s3, 2
    s_cselect_b32 s53, 0, 1
    s_add_u32 s53, s53, s50
    s_mul_i32 s53, s53, 54
    s_add_u32 s53, s53, s52
    s_lshl_b32 s53, s53, 10
    s_add_u32 s57, s53, 0
    s_cmp_eq_u32 s3, 0
    s_cselect_b32 s53, 5, 4
    s_add_u32 s53, s53, s50
    s_mul_i32 s53, s53, 54
    s_add_u32 s53, s53, s52
    s_lshl_b32 s53, s53, 10
    s_add_u32 s58, s53, 0
    s_cmp_eq_u32 s3, 0
    s_cselect_b32 s53, 4, 5
    s_add_u32 s53, s53, s50
    s_mul_i32 s53, s53, 54
    s_add_u32 s53, s53, s52
    s_lshl_b32 s53, s53, 10
    s_add_u32 s59, s53, 0
    s_and_b32 s51, s3, 1
    s_add_u32 s50, s50, s51
    s_cmp_lt_u32 s3, 2
    s_cselect_b32 s51, 4, 0
    s_add_u32 s50, s50, s51
    s_mul_i32 s50, s50, 20480
    s_mul_i32 s51, s62, 160
    s_add_u32 s67, s50, s51
    s_cmp_lg_u32 s3, 0
    s_cbranch_scc1 standalone__swiglu_ffn__prompt_kernel_p0_nospin
    s_mov_b32 s63, 0
standalone__swiglu_ffn__prompt_kernel_sa_p0:
    v_min_u32 v3, 39, v1
    v_lshlrev_b32 v3, 7, v3
    s_mov_b32 s50, 12845056
    buffer_load_dword v25, v3, s[20:23], s50 offen sc1
    s_add_u32 s63, s63, 1
    s_cmp_ge_u32 s63, 60000
    s_cbranch_scc1 standalone__swiglu_ffn__prompt_kernel_sa_ok_p0
    s_waitcnt vmcnt(0)
    v_cmp_ne_u32 vcc, s45, v25
    s_nop 3
    s_cmp_eq_u64 vcc, 0
    s_cbranch_scc1 standalone__swiglu_ffn__prompt_kernel_sa_ok_p0
    s_sleep 2
    s_branch standalone__swiglu_ffn__prompt_kernel_sa_p0
standalone__swiglu_ffn__prompt_kernel_sa_ok_p0:
    s_cmp_lg_u32 s2, 216
    s_cbranch_scc1 standalone__swiglu_ffn__prompt_kernel_p0_nomaster
    v_mov_b32 v2, 0
    v_mov_b32 v3, s45
    s_mov_b32 s4, 12910720
    s_mov_b64 exec, 1
    buffer_store_dword v3, v2, s[20:23], s4 offen sc1
    s_mov_b64 exec, -1
    s_mov_b32 s63, 0
    v_lshlrev_b32 v2, 2, v1
    s_mov_b32 s4, 12914688
standalone__swiglu_ffn__prompt_kernel_ms_spin:
    buffer_load_dword v24, v2, s[20:23], s4 offen sc1
    buffer_load_dword v25, v2, s[20:23], s4 offen offset:256 sc1
    buffer_load_dword v26, v2, s[20:23], s4 offen offset:512 sc1
    buffer_load_dword v27, v2, s[20:23], s4 offen offset:768 sc1
    s_add_u32 s63, s63, 1
    s_cmp_ge_u32 s63, 60000
    s_cbranch_scc1 standalone__swiglu_ffn__prompt_kernel_p0_nomaster
    s_waitcnt vmcnt(0)
    v_xor_b32 v24, s45, v24
    v_xor_b32 v25, s45, v25
    v_xor_b32 v26, s45, v26
    v_xor_b32 v27, s45, v27
    v_or_b32 v24, v24, v25
    v_or_b32 v26, v26, v27
    v_or_b32 v24, v24, v26
    v_cmp_ne_u32 vcc, 0, v24
    s_nop 3
    s_cmp_eq_u64 vcc, 0
    s_cbranch_scc1 standalone__swiglu_ffn__prompt_kernel_ms_ok
    s_sleep 8
    s_branch standalone__swiglu_ffn__prompt_kernel_ms_spin
standalone__swiglu_ffn__prompt_kernel_ms_ok:
    v_mov_b32 v2, 0
    v_mov_b32 v3, s45
    s_mov_b32 s4, 12910592
    s_mov_b32 s5, 12910720
    s_mov_b64 exec, 1
    buffer_store_dword v3, v2, s[20:23], s4 offen sc1
    s_mov_b64 exec, -1
standalone__swiglu_ffn__prompt_kernel_p0_nomaster:
standalone__swiglu_ffn__prompt_kernel_p0_nospin:
    s_barrier
    s_cmp_ge_u32 s3, 2
    s_cbranch_scc1 standalone__swiglu_ffn__prompt_kernel_wd0skip_p0
    buffer_load_dwordx4 a[96:99], v22, s[20:23], s66 offen sc1
    buffer_load_dwordx4 a[100:103], v22, s[20:23], s66 offen offset:1024 sc1
    buffer_load_dwordx4 a[104:107], v22, s[20:23], s66 offen offset:2048 sc1
    buffer_load_dwordx4 a[108:111], v22, s[20:23], s66 offen offset:3072 sc1
    buffer_load_dwordx4 a[112:115], v125, s[20:23], s66 offen sc1
standalone__swiglu_ffn__prompt_kernel_wd0skip_p0:
    buffer_load_dwordx4 a[116:119], v22, s[20:23], s60 offen sc1
    buffer_load_dwordx4 a[120:123], v22, s[20:23], s60 offen offset:1024 sc1
    buffer_load_dwordx4 a[124:127], v22, s[20:23], s60 offen offset:2048 sc1
    buffer_load_dwordx4 a[128:131], v22, s[20:23], s60 offen offset:3072 sc1
    buffer_load_dwordx4 a[132:135], v125, s[20:23], s60 offen sc1
    s_add_u32 s60, s60, 40960
    buffer_load_dwordx4 a[136:139], v22, s[20:23], s60 offen sc1
    buffer_load_dwordx4 a[140:143], v22, s[20:23], s60 offen offset:1024 sc1
    buffer_load_dwordx4 a[144:147], v22, s[20:23], s60 offen offset:2048 sc1
    buffer_load_dwordx4 a[148:151], v22, s[20:23], s60 offen offset:3072 sc1
    buffer_load_dwordx4 a[152:155], v125, s[20:23], s60 offen sc1
    s_add_u32 s60, s60, 40960
    buffer_load_dwordx4 a[156:159], v22, s[20:23], s60 offen sc1
    buffer_load_dwordx4 a[160:163], v22, s[20:23], s60 offen offset:1024 sc1
    buffer_load_dwordx4 a[164:167], v22, s[20:23], s60 offen offset:2048 sc1
    buffer_load_dwordx4 a[168:171], v22, s[20:23], s60 offen offset:3072 sc1
    buffer_load_dwordx4 a[172:175], v125, s[20:23], s60 offen sc1
    s_add_u32 s60, s60, 40960
    buffer_load_dwordx4 a[176:179], v22, s[20:23], s60 offen sc1
    buffer_load_dwordx4 a[180:183], v22, s[20:23], s60 offen offset:1024 sc1
    buffer_load_dwordx4 a[184:187], v22, s[20:23], s60 offen offset:2048 sc1
    buffer_load_dwordx4 a[188:191], v22, s[20:23], s60 offen offset:3072 sc1
    buffer_load_dwordx4 a[192:195], v125, s[20:23], s60 offen sc1
    s_add_u32 s60, s60, 40960
    buffer_load_dwordx4 a[196:199], v22, s[20:23], s60 offen sc1
    buffer_load_dwordx4 a[200:203], v22, s[20:23], s60 offen offset:1024 sc1
    buffer_load_dwordx4 a[204:207], v22, s[20:23], s60 offen offset:2048 sc1
    buffer_load_dwordx4 a[208:211], v22, s[20:23], s60 offen offset:3072 sc1
    buffer_load_dwordx4 a[212:215], v125, s[20:23], s60 offen sc1
    s_add_u32 s60, s60, 40960
    buffer_load_dwordx4 a[216:219], v22, s[20:23], s60 offen sc1
    buffer_load_dwordx4 a[220:223], v22, s[20:23], s60 offen offset:1024 sc1
    buffer_load_dwordx4 a[224:227], v22, s[20:23], s60 offen offset:2048 sc1
    buffer_load_dwordx4 a[228:231], v22, s[20:23], s60 offen offset:3072 sc1
    buffer_load_dwordx4 a[232:235], v125, s[20:23], s60 offen sc1
    s_add_u32 s60, s60, 40960
    buffer_load_dwordx4 a[236:239], v22, s[20:23], s60 offen sc1
    buffer_load_dwordx4 a[240:243], v22, s[20:23], s60 offen offset:1024 sc1
    buffer_load_dwordx4 a[244:247], v22, s[20:23], s60 offen offset:2048 sc1
    buffer_load_dwordx4 a[248:251], v22, s[20:23], s60 offen offset:3072 sc1
    buffer_load_dwordx4 a[252:255], v125, s[20:23], s60 offen sc1
    s_add_u32 s60, s60, 40960
    buffer_load_dwordx4 v[64:67], v22, s[20:23], s60 offen sc1
    buffer_load_dwordx4 v[68:71], v22, s[20:23], s60 offen offset:1024 sc1
    buffer_load_dwordx4 v[72:75], v22, s[20:23], s60 offen offset:2048 sc1
    buffer_load_dwordx4 v[76:79], v22, s[20:23], s60 offen offset:3072 sc1
    buffer_load_dwordx4 v[80:83], v125, s[20:23], s60 offen sc1
    s_add_u32 s60, s60, 40960
    buffer_load_dwordx4 v[84:87], v22, s[20:23], s60 offen sc1
    buffer_load_dwordx4 v[88:91], v22, s[20:23], s60 offen offset:1024 sc1
    buffer_load_dwordx4 v[92:95], v22, s[20:23], s60 offen offset:2048 sc1
    buffer_load_dwordx4 v[96:99], v22, s[20:23], s60 offen offset:3072 sc1
    buffer_load_dwordx4 v[100:103], v125, s[20:23], s60 offen sc1
    s_add_u32 s60, s60, 40960
    buffer_load_dwordx4 v[104:107], v22, s[20:23], s60 offen sc1
    buffer_load_dwordx4 v[108:111], v22, s[20:23], s60 offen offset:1024 sc1
    buffer_load_dwordx4 v[112:115], v22, s[20:23], s60 offen offset:2048 sc1
    buffer_load_dwordx4 v[116:119], v22, s[20:23], s60 offen offset:3072 sc1
    buffer_load_dwordx4 v[120:123], v125, s[20:23], s60 offen sc1
    s_add_u32 s60, s60, 40960
    buffer_load_dwordx4 a[0:3], v22, s[20:23], s60 offen sc1
    buffer_load_dwordx4 a[4:7], v22, s[20:23], s60 offen offset:1024 sc1
    buffer_load_dwordx4 a[8:11], v22, s[20:23], s60 offen offset:2048 sc1
    buffer_load_dwordx4 a[12:15], v22, s[20:23], s60 offen offset:3072 sc1
    buffer_load_dwordx4 a[16:19], v125, s[20:23], s60 offen sc1
    s_add_u32 s60, s60, 40960
    buffer_load_dwordx4 a[20:23], v22, s[20:23], s60 offen sc1
    buffer_load_dwordx4 a[24:27], v22, s[20:23], s60 offen offset:1024 sc1
    buffer_load_dwordx4 a[28:31], v22, s[20:23], s60 offen offset:2048 sc1
    buffer_load_dwordx4 a[32:35], v22, s[20:23], s60 offen offset:3072 sc1
    buffer_load_dwordx4 a[36:39], v125, s[20:23], s60 offen sc1
    s_add_u32 s60, s60, 40960
    buffer_load_dwordx4 a[40:43], v22, s[20:23], s60 offen sc1
    buffer_load_dwordx4 a[44:47], v22, s[20:23], s60 offen offset:1024 sc1
    buffer_load_dwordx4 a[48:51], v22, s[20:23], s60 offen offset:2048 sc1
    buffer_load_dwordx4 a[52:55], v22, s[20:23], s60 offen offset:3072 sc1
    buffer_load_dwordx4 a[56:59], v125, s[20:23], s60 offen sc1
    s_add_u32 s60, s60, 40960
    s_mov_b32 s6, 0
    v_min_u32 v3, 13, v1
    v_lshlrev_b32 v23, 8, v3
standalone__swiglu_ffn__prompt_kernel_p2:
    s_mov_b32 s63, 0
standalone__swiglu_ffn__prompt_kernel_spinE:
    buffer_load_dword v124, v23, s[20:23], s64 offen sc1
    s_add_u32 s63, s63, 1
    s_waitcnt vmcnt(0)
    v_cmp_ne_u32 vcc, s45, v124
    s_cmp_ge_u32 s63, 60000
    s_cbranch_scc1 standalone__swiglu_ffn__prompt_kernel_polledE
    s_cmp_eq_u64 vcc, 0
    s_cbranch_scc1 standalone__swiglu_ffn__prompt_kernel_polledE
    s_sleep 1
    s_branch standalone__swiglu_ffn__prompt_kernel_spinE
    s_branch standalone__swiglu_ffn__prompt_kernel_pg5
.p2align 12
standalone__swiglu_ffn__prompt_kernel_stub5:
    s_setpc_b64 s[4:5]
standalone__swiglu_ffn__prompt_kernel_pg5:
standalone__swiglu_ffn__prompt_kernel_polledE:
    s_cmp_ge_u32 s3, 2
    s_cbranch_scc1 standalone__swiglu_ffn__prompt_kernel_clsB
    buffer_load_dwordx4 a[60:63], v22, s[20:23], s56 offen offset:1024 sc1
    buffer_load_dwordx4 a[64:67], v22, s[20:23], s57 offen offset:1024 sc1
    buffer_load_dwordx4 a[68:71], v22, s[20:23], s56 offen sc1
    buffer_load_dwordx4 a[72:75], v22, s[20:23], s57 offen sc1
    buffer_load_dwordx4 a[76:79], v22, s[20:23], s56 offen offset:2048 sc1
    buffer_load_dwordx4 a[80:83], v22, s[20:23], s57 offen offset:2048 sc1
    buffer_load_dwordx4 a[84:87], v22, s[20:23], s56 offen offset:3072 sc1
    buffer_load_dwordx4 a[88:91], v22, s[20:23], s57 offen offset:3072 sc1
    s_min_u32 s51, s3, 2
    s_mul_i32 s51, s51, 5120
    s_cmp_eq_u32 s3, 2
    s_cselect_b32 s50, 15360, 0
    s_add_u32 s50, s50, 30720
    s_add_u32 s50, s50, s51
    v_add_u32 v6, s50, v22
    s_add_u32 s51, s51, 46080
    v_add_u32 v7, s51, v22
    s_sub_u32 s51, s3, 1
    s_max_i32 s51, s51, 0
    s_mul_i32 s51, s51, 5120
    s_cmp_eq_u32 s3, 0
    s_cselect_b32 s50, 15360, 0
    s_add_u32 s50, s50, s51
    v_add_u32 v8, s50, v22
    s_add_u32 s51, s51, 15360
    v_add_u32 v9, s51, v22
    s_mul_i32 s50, s3, 15360
    v_add_u32 v10, s50, v22
    v_and_b32 v2, 15, v1
    v_lshrrev_b32 v3, 4, v1
    v_mul_u32_u24 v2, 1280, v2
    v_lshl_add_u32 v11, v3, 3, v2
    buffer_load_dwordx4 v[208:211], v125, s[20:23], s56 offen sc1
    buffer_load_dwordx4 v[212:215], v125, s[20:23], s57 offen sc1
    buffer_load_dwordx4 v[216:219], v125, s[20:23], s56 offen offset:1024 sc1
    buffer_load_dwordx4 v[220:223], v125, s[20:23], s57 offen offset:1024 sc1
    buffer_load_dwordx4 v[224:227], v125, s[20:23], s56 offen offset:2048 sc1
    buffer_load_dwordx4 v[228:231], v125, s[20:23], s57 offen offset:2048 sc1
    s_waitcnt vmcnt(12)
    v_mfma_f32_16x16x32_bf16 v[128:131], a[116:119], a[60:63], 0
    v_mfma_f32_16x16x32_bf16 v[132:135], a[120:123], a[60:63], 0
    buffer_load_dwordx4 v[232:235], v125, s[20:23], s56 offen offset:3072 sc1
    v_mfma_f32_16x16x32_bf16 v[136:139], a[124:127], a[60:63], 0
    v_mfma_f32_16x16x32_bf16 v[140:143], a[128:131], a[60:63], 0
    v_mfma_f32_16x16x32_bf16 v[144:147], a[132:135], a[60:63], 0
    v_mfma_f32_16x16x32_bf16 v[148:151], a[116:119], a[64:67], 0
    buffer_load_dwordx4 v[236:239], v125, s[20:23], s57 offen offset:3072 sc1
    v_mfma_f32_16x16x32_bf16 v[152:155], a[120:123], a[64:67], 0
    v_mfma_f32_16x16x32_bf16 v[156:159], a[124:127], a[64:67], 0
    v_mfma_f32_16x16x32_bf16 v[160:163], a[128:131], a[64:67], 0
    v_mfma_f32_16x16x32_bf16 v[164:167], a[132:135], a[64:67], 0
    s_waitcnt vmcnt(12)
    v_mfma_f32_16x16x32_bf16 v[128:131], a[96:99], a[68:71], v[128:131]
    v_mfma_f32_16x16x32_bf16 v[132:135], a[100:103], a[68:71], v[132:135]
    buffer_load_dwordx4 v[240:243], v126, s[20:23], s56 offen sc1
    v_mfma_f32_16x16x32_bf16 v[136:139], a[104:107], a[68:71], v[136:139]
    v_mfma_f32_16x16x32_bf16 v[140:143], a[108:111], a[68:71], v[140:143]
    v_mfma_f32_16x16x32_bf16 v[144:147], a[112:115], a[68:71], v[144:147]
    v_mfma_f32_16x16x32_bf16 v[148:151], a[96:99], a[72:75], v[148:151]
    buffer_load_dwordx4 v[244:247], v126, s[20:23], s57 offen sc1
    v_mfma_f32_16x16x32_bf16 v[152:155], a[100:103], a[72:75], v[152:155]
    v_mfma_f32_16x16x32_bf16 v[156:159], a[104:107], a[72:75], v[156:159]
    v_mfma_f32_16x16x32_bf16 v[160:163], a[108:111], a[72:75], v[160:163]
    v_mfma_f32_16x16x32_bf16 v[164:167], a[112:115], a[72:75], v[164:167]
    s_waitcnt vmcnt(12)
    v_mfma_f32_16x16x32_bf16 v[128:131], a[136:139], a[76:79], v[128:131]
    v_mfma_f32_16x16x32_bf16 v[132:135], a[140:143], a[76:79], v[132:135]
    buffer_load_dwordx4 v[248:251], v126, s[20:23], s56 offen offset:1024 sc1
    v_mfma_f32_16x16x32_bf16 v[136:139], a[144:147], a[76:79], v[136:139]
    v_mfma_f32_16x16x32_bf16 v[140:143], a[148:151], a[76:79], v[140:143]
    v_mfma_f32_16x16x32_bf16 v[144:147], a[152:155], a[76:79], v[144:147]
    v_mfma_f32_16x16x32_bf16 v[148:151], a[136:139], a[80:83], v[148:151]
    buffer_load_dwordx4 v[252:255], v126, s[20:23], s57 offen offset:1024 sc1
    v_mfma_f32_16x16x32_bf16 v[152:155], a[140:143], a[80:83], v[152:155]
    v_mfma_f32_16x16x32_bf16 v[156:159], a[144:147], a[80:83], v[156:159]
    v_mfma_f32_16x16x32_bf16 v[160:163], a[148:151], a[80:83], v[160:163]
    v_mfma_f32_16x16x32_bf16 v[164:167], a[152:155], a[80:83], v[164:167]
    s_waitcnt vmcnt(12)
    v_mfma_f32_16x16x32_bf16 v[128:131], a[156:159], a[84:87], v[128:131]
    v_mfma_f32_16x16x32_bf16 v[132:135], a[160:163], a[84:87], v[132:135]
    buffer_load_dwordx4 v[24:27], v126, s[20:23], s56 offen offset:2048 sc1
    v_mfma_f32_16x16x32_bf16 v[136:139], a[164:167], a[84:87], v[136:139]
    v_mfma_f32_16x16x32_bf16 v[140:143], a[168:171], a[84:87], v[140:143]
    v_mfma_f32_16x16x32_bf16 v[144:147], a[172:175], a[84:87], v[144:147]
    v_mfma_f32_16x16x32_bf16 v[148:151], a[156:159], a[88:91], v[148:151]
    buffer_load_dwordx4 v[28:31], v126, s[20:23], s57 offen offset:2048 sc1
    v_mfma_f32_16x16x32_bf16 v[152:155], a[160:163], a[88:91], v[152:155]
    v_mfma_f32_16x16x32_bf16 v[156:159], a[164:167], a[88:91], v[156:159]
    v_mfma_f32_16x16x32_bf16 v[160:163], a[168:171], a[88:91], v[160:163]
    v_mfma_f32_16x16x32_bf16 v[164:167], a[172:175], a[88:91], v[164:167]
    s_waitcnt vmcnt(12)
    v_mfma_f32_16x16x32_bf16 v[128:131], a[176:179], v[208:211], v[128:131]
    v_mfma_f32_16x16x32_bf16 v[132:135], a[180:183], v[208:211], v[132:135]
    buffer_load_dwordx4 v[32:35], v126, s[20:23], s56 offen offset:3072 sc1
    v_mfma_f32_16x16x32_bf16 v[136:139], a[184:187], v[208:211], v[136:139]
    v_mfma_f32_16x16x32_bf16 v[140:143], a[188:191], v[208:211], v[140:143]
    v_mfma_f32_16x16x32_bf16 v[144:147], a[192:195], v[208:211], v[144:147]
    v_mfma_f32_16x16x32_bf16 v[148:151], a[176:179], v[212:215], v[148:151]
    buffer_load_dwordx4 v[36:39], v126, s[20:23], s57 offen offset:3072 sc1
    v_mfma_f32_16x16x32_bf16 v[152:155], a[180:183], v[212:215], v[152:155]
    v_mfma_f32_16x16x32_bf16 v[156:159], a[184:187], v[212:215], v[156:159]
    v_mfma_f32_16x16x32_bf16 v[160:163], a[188:191], v[212:215], v[160:163]
    v_mfma_f32_16x16x32_bf16 v[164:167], a[192:195], v[212:215], v[164:167]
    s_waitcnt vmcnt(12)
    v_mfma_f32_16x16x32_bf16 v[128:131], a[196:199], v[216:219], v[128:131]
    v_mfma_f32_16x16x32_bf16 v[132:135], a[200:203], v[216:219], v[132:135]
    buffer_load_dwordx4 v[40:43], v127, s[20:23], s56 offen sc1
    v_mfma_f32_16x16x32_bf16 v[136:139], a[204:207], v[216:219], v[136:139]
    v_mfma_f32_16x16x32_bf16 v[140:143], a[208:211], v[216:219], v[140:143]
    v_mfma_f32_16x16x32_bf16 v[144:147], a[212:215], v[216:219], v[144:147]
    v_mfma_f32_16x16x32_bf16 v[148:151], a[196:199], v[220:223], v[148:151]
    buffer_load_dwordx4 v[44:47], v127, s[20:23], s57 offen sc1
    v_mfma_f32_16x16x32_bf16 v[152:155], a[200:203], v[220:223], v[152:155]
    v_mfma_f32_16x16x32_bf16 v[156:159], a[204:207], v[220:223], v[156:159]
    v_mfma_f32_16x16x32_bf16 v[160:163], a[208:211], v[220:223], v[160:163]
    v_mfma_f32_16x16x32_bf16 v[164:167], a[212:215], v[220:223], v[164:167]
    s_waitcnt vmcnt(12)
    v_mfma_f32_16x16x32_bf16 v[128:131], a[216:219], v[224:227], v[128:131]
    v_mfma_f32_16x16x32_bf16 v[132:135], a[220:223], v[224:227], v[132:135]
    buffer_load_dwordx4 v[48:51], v127, s[20:23], s56 offen offset:1024 sc1
    v_mfma_f32_16x16x32_bf16 v[136:139], a[224:227], v[224:227], v[136:139]
    v_mfma_f32_16x16x32_bf16 v[140:143], a[228:231], v[224:227], v[140:143]
    v_mfma_f32_16x16x32_bf16 v[144:147], a[232:235], v[224:227], v[144:147]
    v_mfma_f32_16x16x32_bf16 v[148:151], a[216:219], v[228:231], v[148:151]
    buffer_load_dwordx4 v[52:55], v127, s[20:23], s57 offen offset:1024 sc1
    v_mfma_f32_16x16x32_bf16 v[152:155], a[220:223], v[228:231], v[152:155]
    v_mfma_f32_16x16x32_bf16 v[156:159], a[224:227], v[228:231], v[156:159]
    v_mfma_f32_16x16x32_bf16 v[160:163], a[228:231], v[228:231], v[160:163]
    v_mfma_f32_16x16x32_bf16 v[164:167], a[232:235], v[228:231], v[164:167]
    s_waitcnt vmcnt(12)
    v_mfma_f32_16x16x32_bf16 v[128:131], a[236:239], v[232:235], v[128:131]
    v_mfma_f32_16x16x32_bf16 v[132:135], a[240:243], v[232:235], v[132:135]
    buffer_load_dword v124, v23, s[20:23], s64 offen offset:128 sc1
    v_mfma_f32_16x16x32_bf16 v[136:139], a[244:247], v[232:235], v[136:139]
    v_mfma_f32_16x16x32_bf16 v[140:143], a[248:251], v[232:235], v[140:143]
    v_mfma_f32_16x16x32_bf16 v[144:147], a[252:255], v[232:235], v[144:147]
    v_mfma_f32_16x16x32_bf16 v[148:151], a[236:239], v[236:239], v[148:151]
    v_mfma_f32_16x16x32_bf16 v[152:155], a[240:243], v[236:239], v[152:155]
    v_mfma_f32_16x16x32_bf16 v[156:159], a[244:247], v[236:239], v[156:159]
    v_mfma_f32_16x16x32_bf16 v[160:163], a[248:251], v[236:239], v[160:163]
    v_mfma_f32_16x16x32_bf16 v[164:167], a[252:255], v[236:239], v[164:167]
    s_waitcnt vmcnt(11)
    v_mfma_f32_16x16x32_bf16 v[128:131], v[64:67], v[240:243], v[128:131]
    v_mfma_f32_16x16x32_bf16 v[132:135], v[68:71], v[240:243], v[132:135]
    v_mfma_f32_16x16x32_bf16 v[136:139], v[72:75], v[240:243], v[136:139]
    v_mfma_f32_16x16x32_bf16 v[140:143], v[76:79], v[240:243], v[140:143]
    v_mfma_f32_16x16x32_bf16 v[144:147], v[80:83], v[240:243], v[144:147]
    v_mfma_f32_16x16x32_bf16 v[148:151], v[64:67], v[244:247], v[148:151]
    v_mfma_f32_16x16x32_bf16 v[152:155], v[68:71], v[244:247], v[152:155]
    v_mfma_f32_16x16x32_bf16 v[156:159], v[72:75], v[244:247], v[156:159]
    v_mfma_f32_16x16x32_bf16 v[160:163], v[76:79], v[244:247], v[160:163]
    v_mfma_f32_16x16x32_bf16 v[164:167], v[80:83], v[244:247], v[164:167]
    s_waitcnt vmcnt(9)
    v_mfma_f32_16x16x32_bf16 v[128:131], v[84:87], v[248:251], v[128:131]
    v_mfma_f32_16x16x32_bf16 v[132:135], v[88:91], v[248:251], v[132:135]
    v_mfma_f32_16x16x32_bf16 v[136:139], v[92:95], v[248:251], v[136:139]
    v_mfma_f32_16x16x32_bf16 v[140:143], v[96:99], v[248:251], v[140:143]
    v_mfma_f32_16x16x32_bf16 v[144:147], v[100:103], v[248:251], v[144:147]
    v_mfma_f32_16x16x32_bf16 v[148:151], v[84:87], v[252:255], v[148:151]
    v_mfma_f32_16x16x32_bf16 v[152:155], v[88:91], v[252:255], v[152:155]
    v_mfma_f32_16x16x32_bf16 v[156:159], v[92:95], v[252:255], v[156:159]
    v_mfma_f32_16x16x32_bf16 v[160:163], v[96:99], v[252:255], v[160:163]
    v_mfma_f32_16x16x32_bf16 v[164:167], v[100:103], v[252:255], v[164:167]
    s_waitcnt vmcnt(0)
    v_cmp_ne_u32 vcc, s45, v124
    s_nop 1
    s_cmp_eq_u64 vcc, 0
    s_cbranch_scc1 standalone__swiglu_ffn__prompt_kernel_polledLA
    s_mov_b32 s63, 0
standalone__swiglu_ffn__prompt_kernel_spinLA:
    buffer_load_dword v124, v23, s[20:23], s64 offen offset:128 sc1
    s_add_u32 s63, s63, 1
    s_waitcnt vmcnt(0)
    v_cmp_ne_u32 vcc, s45, v124
    s_cmp_ge_u32 s63, 60000
    s_cbranch_scc1 standalone__swiglu_ffn__prompt_kernel_polledLA
    s_cmp_eq_u64 vcc, 0
    s_cbranch_scc1 standalone__swiglu_ffn__prompt_kernel_polledLA
    s_sleep 1
    s_branch standalone__swiglu_ffn__prompt_kernel_spinLA
standalone__swiglu_ffn__prompt_kernel_polledLA:
    s_waitcnt vmcnt(7)
    v_mfma_f32_16x16x32_bf16 v[128:131], v[104:107], v[24:27], v[128:131]
    v_mfma_f32_16x16x32_bf16 v[132:135], v[108:111], v[24:27], v[132:135]
    buffer_load_dwordx4 a[60:63], v22, s[20:23], s58 offen offset:1024 sc1
    v_mfma_f32_16x16x32_bf16 v[136:139], v[112:115], v[24:27], v[136:139]
    v_mfma_f32_16x16x32_bf16 v[140:143], v[116:119], v[24:27], v[140:143]
    v_mfma_f32_16x16x32_bf16 v[144:147], v[120:123], v[24:27], v[144:147]
    v_mfma_f32_16x16x32_bf16 v[148:151], v[104:107], v[28:31], v[148:151]
    buffer_load_dwordx4 a[64:67], v22, s[20:23], s59 offen offset:1024 sc1
    v_mfma_f32_16x16x32_bf16 v[152:155], v[108:111], v[28:31], v[152:155]
    v_mfma_f32_16x16x32_bf16 v[156:159], v[112:115], v[28:31], v[156:159]
    v_mfma_f32_16x16x32_bf16 v[160:163], v[116:119], v[28:31], v[160:163]
    v_mfma_f32_16x16x32_bf16 v[164:167], v[120:123], v[28:31], v[164:167]
    s_waitcnt vmcnt(7)
    v_mfma_f32_16x16x32_bf16 v[128:131], a[0:3], v[32:35], v[128:131]
    v_mfma_f32_16x16x32_bf16 v[132:135], a[4:7], v[32:35], v[132:135]
    buffer_load_dwordx4 a[68:71], v22, s[20:23], s58 offen sc1
    v_mfma_f32_16x16x32_bf16 v[136:139], a[8:11], v[32:35], v[136:139]
    v_mfma_f32_16x16x32_bf16 v[140:143], a[12:15], v[32:35], v[140:143]
    v_mfma_f32_16x16x32_bf16 v[144:147], a[16:19], v[32:35], v[144:147]
    v_mfma_f32_16x16x32_bf16 v[148:151], a[0:3], v[36:39], v[148:151]
    buffer_load_dwordx4 a[72:75], v22, s[20:23], s59 offen sc1
    v_mfma_f32_16x16x32_bf16 v[152:155], a[4:7], v[36:39], v[152:155]
    v_mfma_f32_16x16x32_bf16 v[156:159], a[8:11], v[36:39], v[156:159]
    v_mfma_f32_16x16x32_bf16 v[160:163], a[12:15], v[36:39], v[160:163]
    v_mfma_f32_16x16x32_bf16 v[164:167], a[16:19], v[36:39], v[164:167]
    s_waitcnt vmcnt(7)
    v_mfma_f32_16x16x32_bf16 v[128:131], a[20:23], v[40:43], v[128:131]
    v_mfma_f32_16x16x32_bf16 v[132:135], a[24:27], v[40:43], v[132:135]
    buffer_load_dwordx4 a[76:79], v22, s[20:23], s58 offen offset:2048 sc1
    v_mfma_f32_16x16x32_bf16 v[136:139], a[28:31], v[40:43], v[136:139]
    v_mfma_f32_16x16x32_bf16 v[140:143], a[32:35], v[40:43], v[140:143]
    v_mfma_f32_16x16x32_bf16 v[144:147], a[36:39], v[40:43], v[144:147]
    v_mfma_f32_16x16x32_bf16 v[148:151], a[20:23], v[44:47], v[148:151]
    buffer_load_dwordx4 a[80:83], v22, s[20:23], s59 offen offset:2048 sc1
    v_mfma_f32_16x16x32_bf16 v[152:155], a[24:27], v[44:47], v[152:155]
    v_mfma_f32_16x16x32_bf16 v[156:159], a[28:31], v[44:47], v[156:159]
    v_mfma_f32_16x16x32_bf16 v[160:163], a[32:35], v[44:47], v[160:163]
    v_mfma_f32_16x16x32_bf16 v[164:167], a[36:39], v[44:47], v[164:167]
    s_waitcnt vmcnt(7)
    v_mfma_f32_16x16x32_bf16 v[128:131], a[40:43], v[48:51], v[128:131]
    v_mfma_f32_16x16x32_bf16 v[132:135], a[44:47], v[48:51], v[132:135]
    buffer_load_dwordx4 a[84:87], v22, s[20:23], s58 offen offset:3072 sc1
    v_mfma_f32_16x16x32_bf16 v[136:139], a[48:51], v[48:51], v[136:139]
    v_mfma_f32_16x16x32_bf16 v[140:143], a[52:55], v[48:51], v[140:143]
    v_mfma_f32_16x16x32_bf16 v[144:147], a[56:59], v[48:51], v[144:147]
    v_mfma_f32_16x16x32_bf16 v[148:151], a[40:43], v[52:55], v[148:151]
    buffer_load_dwordx4 a[88:91], v22, s[20:23], s59 offen offset:3072 sc1
    v_mfma_f32_16x16x32_bf16 v[152:155], a[44:47], v[52:55], v[152:155]
    v_mfma_f32_16x16x32_bf16 v[156:159], a[48:51], v[52:55], v[156:159]
    v_mfma_f32_16x16x32_bf16 v[160:163], a[52:55], v[52:55], v[160:163]
    v_mfma_f32_16x16x32_bf16 v[164:167], a[56:59], v[52:55], v[164:167]
    s_waitcnt vmcnt(6)
    v_mfma_f32_16x16x32_bf16 v[168:171], a[116:119], a[60:63], 0
    v_mfma_f32_16x16x32_bf16 v[172:175], a[120:123], a[60:63], 0
    buffer_load_dwordx4 v[208:211], v125, s[20:23], s58 offen sc1
    v_mfma_f32_16x16x32_bf16 v[176:179], a[124:127], a[60:63], 0
    v_mfma_f32_16x16x32_bf16 v[180:183], a[128:131], a[60:63], 0
    buffer_load_dwordx4 v[212:215], v125, s[20:23], s59 offen sc1
    v_mfma_f32_16x16x32_bf16 v[184:187], a[132:135], a[60:63], 0
    ds_write_b128 v6, v[128:131] offset:0
    v_mfma_f32_16x16x32_bf16 v[188:191], a[116:119], a[64:67], 0
    ds_write_b128 v6, v[132:135] offset:1024
    v_mfma_f32_16x16x32_bf16 v[192:195], a[120:123], a[64:67], 0
    ds_write_b128 v6, v[136:139] offset:2048
    buffer_load_dwordx4 v[216:219], v125, s[20:23], s58 offen offset:1024 sc1
    v_mfma_f32_16x16x32_bf16 v[196:199], a[124:127], a[64:67], 0
    ds_write_b128 v6, v[140:143] offset:3072
    v_mfma_f32_16x16x32_bf16 v[200:203], a[128:131], a[64:67], 0
    ds_write_b128 v6, v[144:147] offset:4096
    v_mfma_f32_16x16x32_bf16 v[204:207], a[132:135], a[64:67], 0
    s_waitcnt vmcnt(7)
    v_mfma_f32_16x16x32_bf16 v[168:171], a[96:99], a[68:71], v[168:171]
    ds_write_b128 v7, v[148:151] offset:0
    v_mfma_f32_16x16x32_bf16 v[172:175], a[100:103], a[68:71], v[172:175]
    buffer_load_dwordx4 v[220:223], v125, s[20:23], s59 offen offset:1024 sc1
    v_mfma_f32_16x16x32_bf16 v[176:179], a[104:107], a[68:71], v[176:179]
    ds_write_b128 v7, v[152:155] offset:1024
    v_mfma_f32_16x16x32_bf16 v[180:183], a[108:111], a[68:71], v[180:183]
    buffer_load_dwordx4 v[224:227], v125, s[20:23], s58 offen offset:2048 sc1
    v_mfma_f32_16x16x32_bf16 v[184:187], a[112:115], a[68:71], v[184:187]
    ds_write_b128 v7, v[156:159] offset:2048
    v_mfma_f32_16x16x32_bf16 v[188:191], a[96:99], a[72:75], v[188:191]
    v_mfma_f32_16x16x32_bf16 v[192:195], a[100:103], a[72:75], v[192:195]
    ds_write_b128 v7, v[160:163] offset:3072
    buffer_load_dwordx4 v[228:231], v125, s[20:23], s59 offen offset:2048 sc1
    v_mfma_f32_16x16x32_bf16 v[196:199], a[104:107], a[72:75], v[196:199]
    v_mfma_f32_16x16x32_bf16 v[200:203], a[108:111], a[72:75], v[200:203]
    ds_write_b128 v7, v[164:167] offset:4096
    v_mfma_f32_16x16x32_bf16 v[204:207], a[112:115], a[72:75], v[204:207]
    s_waitcnt vmcnt(8)
    v_mfma_f32_16x16x32_bf16 v[168:171], a[136:139], a[76:79], v[168:171]
    v_mfma_f32_16x16x32_bf16 v[172:175], a[140:143], a[76:79], v[172:175]
    buffer_load_dwordx4 v[232:235], v125, s[20:23], s58 offen offset:3072 sc1
    v_mfma_f32_16x16x32_bf16 v[176:179], a[144:147], a[76:79], v[176:179]
    v_mfma_f32_16x16x32_bf16 v[180:183], a[148:151], a[76:79], v[180:183]
    buffer_load_dwordx4 v[236:239], v125, s[20:23], s59 offen offset:3072 sc1
    v_mfma_f32_16x16x32_bf16 v[184:187], a[152:155], a[76:79], v[184:187]
    v_mfma_f32_16x16x32_bf16 v[188:191], a[136:139], a[80:83], v[188:191]
    v_mfma_f32_16x16x32_bf16 v[192:195], a[140:143], a[80:83], v[192:195]
    buffer_load_dwordx4 v[240:243], v126, s[20:23], s58 offen sc1
    v_mfma_f32_16x16x32_bf16 v[196:199], a[144:147], a[80:83], v[196:199]
    v_mfma_f32_16x16x32_bf16 v[200:203], a[148:151], a[80:83], v[200:203]
    v_mfma_f32_16x16x32_bf16 v[204:207], a[152:155], a[80:83], v[204:207]
    s_waitcnt vmcnt(9)
    v_mfma_f32_16x16x32_bf16 v[168:171], a[156:159], a[84:87], v[168:171]
    v_mfma_f32_16x16x32_bf16 v[172:175], a[160:163], a[84:87], v[172:175]
    buffer_load_dwordx4 v[244:247], v126, s[20:23], s59 offen sc1
    v_mfma_f32_16x16x32_bf16 v[176:179], a[164:167], a[84:87], v[176:179]
    v_mfma_f32_16x16x32_bf16 v[180:183], a[168:171], a[84:87], v[180:183]
    buffer_load_dwordx4 v[248:251], v126, s[20:23], s58 offen offset:1024 sc1
    v_mfma_f32_16x16x32_bf16 v[184:187], a[172:175], a[84:87], v[184:187]
    v_mfma_f32_16x16x32_bf16 v[188:191], a[156:159], a[88:91], v[188:191]
    v_mfma_f32_16x16x32_bf16 v[192:195], a[160:163], a[88:91], v[192:195]
    buffer_load_dwordx4 v[252:255], v126, s[20:23], s59 offen offset:1024 sc1
    v_mfma_f32_16x16x32_bf16 v[196:199], a[164:167], a[88:91], v[196:199]
    v_mfma_f32_16x16x32_bf16 v[200:203], a[168:171], a[88:91], v[200:203]
    v_mfma_f32_16x16x32_bf16 v[204:207], a[172:175], a[88:91], v[204:207]
    s_waitcnt vmcnt(10)
    s_waitcnt lgkmcnt(0)
    s_barrier
    v_mfma_f32_16x16x32_bf16 v[168:171], a[176:179], v[208:211], v[168:171]
    v_mfma_f32_16x16x32_bf16 v[172:175], a[180:183], v[208:211], v[172:175]
    buffer_load_dwordx4 v[24:27], v126, s[20:23], s58 offen offset:2048 sc1
    v_mfma_f32_16x16x32_bf16 v[176:179], a[184:187], v[208:211], v[176:179]
    v_mfma_f32_16x16x32_bf16 v[180:183], a[188:191], v[208:211], v[180:183]
    buffer_load_dwordx4 v[28:31], v126, s[20:23], s59 offen offset:2048 sc1
    v_mfma_f32_16x16x32_bf16 v[184:187], a[192:195], v[208:211], v[184:187]
    v_mfma_f32_16x16x32_bf16 v[188:191], a[176:179], v[212:215], v[188:191]
    v_mfma_f32_16x16x32_bf16 v[192:195], a[180:183], v[212:215], v[192:195]
    buffer_load_dwordx4 v[32:35], v126, s[20:23], s58 offen offset:3072 sc1
    v_mfma_f32_16x16x32_bf16 v[196:199], a[184:187], v[212:215], v[196:199]
    v_mfma_f32_16x16x32_bf16 v[200:203], a[188:191], v[212:215], v[200:203]
    v_mfma_f32_16x16x32_bf16 v[204:207], a[192:195], v[212:215], v[204:207]
    s_waitcnt vmcnt(11)
    v_mfma_f32_16x16x32_bf16 v[168:171], a[196:199], v[216:219], v[168:171]
    v_mfma_f32_16x16x32_bf16 v[172:175], a[200:203], v[216:219], v[172:175]
    buffer_load_dwordx4 v[36:39], v126, s[20:23], s59 offen offset:3072 sc1
    v_mfma_f32_16x16x32_bf16 v[176:179], a[204:207], v[216:219], v[176:179]
    v_mfma_f32_16x16x32_bf16 v[180:183], a[208:211], v[216:219], v[180:183]
    buffer_load_dwordx4 v[40:43], v127, s[20:23], s58 offen sc1
    v_mfma_f32_16x16x32_bf16 v[184:187], a[212:215], v[216:219], v[184:187]
    v_mfma_f32_16x16x32_bf16 v[188:191], a[196:199], v[220:223], v[188:191]
    v_mfma_f32_16x16x32_bf16 v[192:195], a[200:203], v[220:223], v[192:195]
    buffer_load_dwordx4 v[44:47], v127, s[20:23], s59 offen sc1
    v_mfma_f32_16x16x32_bf16 v[196:199], a[204:207], v[220:223], v[196:199]
    v_mfma_f32_16x16x32_bf16 v[200:203], a[208:211], v[220:223], v[200:203]
    v_mfma_f32_16x16x32_bf16 v[204:207], a[212:215], v[220:223], v[204:207]
    s_waitcnt vmcnt(12)
    v_mfma_f32_16x16x32_bf16 v[168:171], a[216:219], v[224:227], v[168:171]
    v_mfma_f32_16x16x32_bf16 v[172:175], a[220:223], v[224:227], v[172:175]
    buffer_load_dwordx4 v[48:51], v127, s[20:23], s58 offen offset:1024 sc1
    v_mfma_f32_16x16x32_bf16 v[176:179], a[224:227], v[224:227], v[176:179]
    v_mfma_f32_16x16x32_bf16 v[180:183], a[228:231], v[224:227], v[180:183]
    v_mfma_f32_16x16x32_bf16 v[184:187], a[232:235], v[224:227], v[184:187]
    v_mfma_f32_16x16x32_bf16 v[188:191], a[216:219], v[228:231], v[188:191]
    buffer_load_dwordx4 v[52:55], v127, s[20:23], s59 offen offset:1024 sc1
    v_mfma_f32_16x16x32_bf16 v[192:195], a[220:223], v[228:231], v[192:195]
    v_mfma_f32_16x16x32_bf16 v[196:199], a[224:227], v[228:231], v[196:199]
    v_mfma_f32_16x16x32_bf16 v[200:203], a[228:231], v[228:231], v[200:203]
    v_mfma_f32_16x16x32_bf16 v[204:207], a[232:235], v[228:231], v[204:207]
    s_waitcnt vmcnt(12)
    v_mfma_f32_16x16x32_bf16 v[168:171], a[236:239], v[232:235], v[168:171]
    v_mfma_f32_16x16x32_bf16 v[172:175], a[240:243], v[232:235], v[172:175]
    v_mfma_f32_16x16x32_bf16 v[176:179], a[244:247], v[232:235], v[176:179]
    v_mfma_f32_16x16x32_bf16 v[180:183], a[248:251], v[232:235], v[180:183]
    v_mfma_f32_16x16x32_bf16 v[184:187], a[252:255], v[232:235], v[184:187]
    v_mfma_f32_16x16x32_bf16 v[188:191], a[236:239], v[236:239], v[188:191]
    v_mfma_f32_16x16x32_bf16 v[192:195], a[240:243], v[236:239], v[192:195]
    v_mfma_f32_16x16x32_bf16 v[196:199], a[244:247], v[236:239], v[196:199]
    v_mfma_f32_16x16x32_bf16 v[200:203], a[248:251], v[236:239], v[200:203]
    v_mfma_f32_16x16x32_bf16 v[204:207], a[252:255], v[236:239], v[204:207]
    s_waitcnt vmcnt(10)
    v_mfma_f32_16x16x32_bf16 v[168:171], v[64:67], v[240:243], v[168:171]
    v_mfma_f32_16x16x32_bf16 v[172:175], v[68:71], v[240:243], v[172:175]
    v_mfma_f32_16x16x32_bf16 v[176:179], v[72:75], v[240:243], v[176:179]
    v_mfma_f32_16x16x32_bf16 v[180:183], v[76:79], v[240:243], v[180:183]
    v_mfma_f32_16x16x32_bf16 v[184:187], v[80:83], v[240:243], v[184:187]
    v_mfma_f32_16x16x32_bf16 v[188:191], v[64:67], v[244:247], v[188:191]
    v_mfma_f32_16x16x32_bf16 v[192:195], v[68:71], v[244:247], v[192:195]
    v_mfma_f32_16x16x32_bf16 v[196:199], v[72:75], v[244:247], v[196:199]
    v_mfma_f32_16x16x32_bf16 v[200:203], v[76:79], v[244:247], v[200:203]
    v_mfma_f32_16x16x32_bf16 v[204:207], v[80:83], v[244:247], v[204:207]
    s_waitcnt vmcnt(8)
    v_mfma_f32_16x16x32_bf16 v[168:171], v[84:87], v[248:251], v[168:171]
    v_mfma_f32_16x16x32_bf16 v[172:175], v[88:91], v[248:251], v[172:175]
    v_mfma_f32_16x16x32_bf16 v[176:179], v[92:95], v[248:251], v[176:179]
    v_mfma_f32_16x16x32_bf16 v[180:183], v[96:99], v[248:251], v[180:183]
    v_mfma_f32_16x16x32_bf16 v[184:187], v[100:103], v[248:251], v[184:187]
    v_mfma_f32_16x16x32_bf16 v[188:191], v[84:87], v[252:255], v[188:191]
    v_mfma_f32_16x16x32_bf16 v[192:195], v[88:91], v[252:255], v[192:195]
    v_mfma_f32_16x16x32_bf16 v[196:199], v[92:95], v[252:255], v[196:199]
    v_mfma_f32_16x16x32_bf16 v[200:203], v[96:99], v[252:255], v[200:203]
    v_mfma_f32_16x16x32_bf16 v[204:207], v[100:103], v[252:255], v[204:207]
    s_waitcnt vmcnt(6)
    v_mfma_f32_16x16x32_bf16 v[168:171], v[104:107], v[24:27], v[168:171]
    v_mfma_f32_16x16x32_bf16 v[172:175], v[108:111], v[24:27], v[172:175]
    v_mfma_f32_16x16x32_bf16 v[176:179], v[112:115], v[24:27], v[176:179]
    v_mfma_f32_16x16x32_bf16 v[180:183], v[116:119], v[24:27], v[180:183]
    v_mfma_f32_16x16x32_bf16 v[184:187], v[120:123], v[24:27], v[184:187]
    v_mfma_f32_16x16x32_bf16 v[188:191], v[104:107], v[28:31], v[188:191]
    v_mfma_f32_16x16x32_bf16 v[192:195], v[108:111], v[28:31], v[192:195]
    v_mfma_f32_16x16x32_bf16 v[196:199], v[112:115], v[28:31], v[196:199]
    v_mfma_f32_16x16x32_bf16 v[200:203], v[116:119], v[28:31], v[200:203]
    v_mfma_f32_16x16x32_bf16 v[204:207], v[120:123], v[28:31], v[204:207]
    s_waitcnt vmcnt(0)
    v_mfma_f32_16x16x32_bf16 v[168:171], a[0:3], v[32:35], v[168:171]
    v_mfma_f32_16x16x32_bf16 v[172:175], a[4:7], v[32:35], v[172:175]
    v_mfma_f32_16x16x32_bf16 v[176:179], a[8:11], v[32:35], v[176:179]
    v_mfma_f32_16x16x32_bf16 v[180:183], a[12:15], v[32:35], v[180:183]
    v_mfma_f32_16x16x32_bf16 v[184:187], a[16:19], v[32:35], v[184:187]
    v_mfma_f32_16x16x32_bf16 v[168:171], a[20:23], v[40:43], v[168:171]
    v_mfma_f32_16x16x32_bf16 v[172:175], a[24:27], v[40:43], v[172:175]
    v_mfma_f32_16x16x32_bf16 v[176:179], a[28:31], v[40:43], v[176:179]
    v_mfma_f32_16x16x32_bf16 v[180:183], a[32:35], v[40:43], v[180:183]
    v_mfma_f32_16x16x32_bf16 v[184:187], a[36:39], v[40:43], v[184:187]
    v_mfma_f32_16x16x32_bf16 v[168:171], a[40:43], v[48:51], v[168:171]
    v_mfma_f32_16x16x32_bf16 v[172:175], a[44:47], v[48:51], v[172:175]
    v_mfma_f32_16x16x32_bf16 v[176:179], a[48:51], v[48:51], v[176:179]
    v_mfma_f32_16x16x32_bf16 v[180:183], a[52:55], v[48:51], v[180:183]
    v_mfma_f32_16x16x32_bf16 v[184:187], a[56:59], v[48:51], v[184:187]
    v_mfma_f32_16x16x32_bf16 v[188:191], a[0:3], v[36:39], v[188:191]
    v_mfma_f32_16x16x32_bf16 v[192:195], a[4:7], v[36:39], v[192:195]
    v_mfma_f32_16x16x32_bf16 v[196:199], a[8:11], v[36:39], v[196:199]
    v_mfma_f32_16x16x32_bf16 v[200:203], a[12:15], v[36:39], v[200:203]
    v_mfma_f32_16x16x32_bf16 v[204:207], a[16:19], v[36:39], v[204:207]
    v_mfma_f32_16x16x32_bf16 v[188:191], a[20:23], v[44:47], v[188:191]
    ds_write_b128 v8, v[168:171] offset:0
    v_mfma_f32_16x16x32_bf16 v[192:195], a[24:27], v[44:47], v[192:195]
    v_mfma_f32_16x16x32_bf16 v[196:199], a[28:31], v[44:47], v[196:199]
    ds_write_b128 v8, v[172:175] offset:1024
    v_mfma_f32_16x16x32_bf16 v[200:203], a[32:35], v[44:47], v[200:203]
    v_mfma_f32_16x16x32_bf16 v[204:207], a[36:39], v[44:47], v[204:207]
    ds_write_b128 v8, v[176:179] offset:2048
    v_mfma_f32_16x16x32_bf16 v[188:191], a[40:43], v[52:55], v[188:191]
    v_mfma_f32_16x16x32_bf16 v[192:195], a[44:47], v[52:55], v[192:195]
    ds_write_b128 v8, v[180:183] offset:3072
    v_mfma_f32_16x16x32_bf16 v[196:199], a[48:51], v[52:55], v[196:199]
    v_mfma_f32_16x16x32_bf16 v[200:203], a[52:55], v[52:55], v[200:203]
    ds_write_b128 v8, v[184:187] offset:4096
    v_mfma_f32_16x16x32_bf16 v[204:207], a[56:59], v[52:55], v[204:207]
    s_waitcnt lgkmcnt(0)
    s_barrier
    ds_read_b128 v[24:27], v10 offset:0
    ds_read_b128 v[28:31], v10 offset:5120
    ds_read_b128 v[32:35], v10 offset:10240
    ds_read_b128 v[36:39], v10 offset:1024
    ds_read_b128 v[40:43], v10 offset:6144
    ds_read_b128 v[44:47], v10 offset:11264
    ds_read_b128 v[48:51], v10 offset:2048
    ds_read_b128 v[52:55], v10 offset:7168
    ds_read_b128 v[56:59], v10 offset:12288
    ds_read_b128 v[60:63], v10 offset:3072
    ds_read_b128 v[64:67], v10 offset:8192
    ds_read_b128 v[68:71], v10 offset:13312
    ds_read_b128 v[72:75], v10 offset:4096
    ds_read_b128 v[76:79], v10 offset:9216
    ds_read_b128 v[80:83], v10 offset:14336
    s_waitcnt lgkmcnt(12)
    v_pk_add_f32 v[188:189], v[188:189], v[24:25]
    v_pk_add_f32 v[190:191], v[190:191], v[26:27]
    v_pk_add_f32 v[188:189], v[188:189], v[28:29]
    v_pk_add_f32 v[190:191], v[190:191], v[30:31]
    v_pk_add_f32 v[188:189], v[188:189], v[32:33]
    v_pk_add_f32 v[190:191], v[190:191], v[34:35]
    v_cvt_pk_bf16_f32 v12, v188, v189
    v_cvt_pk_bf16_f32 v13, v190, v191
    buffer_store_dwordx2 v[12:13], v11, s[28:31], s67 offen offset:0
    s_waitcnt lgkmcnt(9)
    v_pk_add_f32 v[192:193], v[192:193], v[36:37]
    v_pk_add_f32 v[194:195], v[194:195], v[38:39]
    v_pk_add_f32 v[192:193], v[192:193], v[40:41]
    v_pk_add_f32 v[194:195], v[194:195], v[42:43]
    v_pk_add_f32 v[192:193], v[192:193], v[44:45]
    v_pk_add_f32 v[194:195], v[194:195], v[46:47]
    v_cvt_pk_bf16_f32 v14, v192, v193
    v_cvt_pk_bf16_f32 v15, v194, v195
    buffer_store_dwordx2 v[14:15], v11, s[28:31], s67 offen offset:32
    s_waitcnt lgkmcnt(6)
    v_pk_add_f32 v[196:197], v[196:197], v[48:49]
    v_pk_add_f32 v[198:199], v[198:199], v[50:51]
    v_pk_add_f32 v[196:197], v[196:197], v[52:53]
    v_pk_add_f32 v[198:199], v[198:199], v[54:55]
    v_pk_add_f32 v[196:197], v[196:197], v[56:57]
    v_pk_add_f32 v[198:199], v[198:199], v[58:59]
    v_cvt_pk_bf16_f32 v16, v196, v197
    v_cvt_pk_bf16_f32 v17, v198, v199
    buffer_store_dwordx2 v[16:17], v11, s[28:31], s67 offen offset:64
    s_waitcnt lgkmcnt(3)
    v_pk_add_f32 v[200:201], v[200:201], v[60:61]
    v_pk_add_f32 v[202:203], v[202:203], v[62:63]
    v_pk_add_f32 v[200:201], v[200:201], v[64:65]
    v_pk_add_f32 v[202:203], v[202:203], v[66:67]
    v_pk_add_f32 v[200:201], v[200:201], v[68:69]
    v_pk_add_f32 v[202:203], v[202:203], v[70:71]
    v_cvt_pk_bf16_f32 v18, v200, v201
    v_cvt_pk_bf16_f32 v19, v202, v203
    buffer_store_dwordx2 v[18:19], v11, s[28:31], s67 offen offset:96
    s_waitcnt lgkmcnt(0)
    v_pk_add_f32 v[204:205], v[204:205], v[72:73]
    v_pk_add_f32 v[206:207], v[206:207], v[74:75]
    v_pk_add_f32 v[204:205], v[204:205], v[76:77]
    v_pk_add_f32 v[206:207], v[206:207], v[78:79]
    v_pk_add_f32 v[204:205], v[204:205], v[80:81]
    v_pk_add_f32 v[206:207], v[206:207], v[82:83]
    v_cvt_pk_bf16_f32 v20, v204, v205
    v_cvt_pk_bf16_f32 v21, v206, v207
    buffer_store_dwordx2 v[20:21], v11, s[28:31], s67 offen offset:128
    s_branch standalone__swiglu_ffn__prompt_kernel_fin
.p2align 12
standalone__swiglu_ffn__prompt_kernel_stub6:
    s_setpc_b64 s[4:5]
standalone__swiglu_ffn__prompt_kernel_pg6:
standalone__swiglu_ffn__prompt_kernel_clsB:
    buffer_load_dwordx4 a[60:63], v22, s[20:23], s56 offen offset:1024 sc1
    buffer_load_dwordx4 a[64:67], v22, s[20:23], s57 offen offset:1024 sc1
    buffer_load_dwordx4 a[76:79], v22, s[20:23], s56 offen offset:2048 sc1
    buffer_load_dwordx4 a[80:83], v22, s[20:23], s57 offen offset:2048 sc1
    buffer_load_dwordx4 a[84:87], v22, s[20:23], s56 offen offset:3072 sc1
    buffer_load_dwordx4 a[88:91], v22, s[20:23], s57 offen offset:3072 sc1
    buffer_load_dwordx4 v[208:211], v125, s[20:23], s56 offen sc1
    buffer_load_dwordx4 v[212:215], v125, s[20:23], s57 offen sc1
    s_min_u32 s51, s3, 2
    s_mul_i32 s51, s51, 5120
    s_cmp_eq_u32 s3, 2
    s_cselect_b32 s50, 15360, 0
    s_add_u32 s50, s50, 30720
    s_add_u32 s50, s50, s51
    v_add_u32 v6, s50, v22
    s_add_u32 s51, s51, 46080
    v_add_u32 v7, s51, v22
    s_sub_u32 s51, s3, 1
    s_max_i32 s51, s51, 0
    s_mul_i32 s51, s51, 5120
    s_cmp_eq_u32 s3, 0
    s_cselect_b32 s50, 15360, 0
    s_add_u32 s50, s50, s51
    v_add_u32 v8, s50, v22
    s_add_u32 s51, s51, 15360
    v_add_u32 v9, s51, v22
    s_mul_i32 s50, s3, 15360
    v_add_u32 v10, s50, v22
    v_and_b32 v2, 15, v1
    v_lshrrev_b32 v3, 4, v1
    v_mul_u32_u24 v2, 1280, v2
    v_lshl_add_u32 v11, v3, 3, v2
    buffer_load_dwordx4 v[216:219], v125, s[20:23], s56 offen offset:1024 sc1
    buffer_load_dwordx4 v[220:223], v125, s[20:23], s57 offen offset:1024 sc1
    buffer_load_dwordx4 v[224:227], v125, s[20:23], s56 offen offset:2048 sc1
    buffer_load_dwordx4 v[228:231], v125, s[20:23], s57 offen offset:2048 sc1
    buffer_load_dwordx4 v[232:235], v125, s[20:23], s56 offen offset:3072 sc1
    buffer_load_dwordx4 v[236:239], v125, s[20:23], s57 offen offset:3072 sc1
    s_waitcnt vmcnt(12)
    v_mfma_f32_16x16x32_bf16 v[128:131], a[116:119], a[60:63], 0
    v_mfma_f32_16x16x32_bf16 v[132:135], a[120:123], a[60:63], 0
    buffer_load_dwordx4 v[240:243], v126, s[20:23], s56 offen sc1
    v_mfma_f32_16x16x32_bf16 v[136:139], a[124:127], a[60:63], 0
    v_mfma_f32_16x16x32_bf16 v[140:143], a[128:131], a[60:63], 0
    v_mfma_f32_16x16x32_bf16 v[144:147], a[132:135], a[60:63], 0
    v_mfma_f32_16x16x32_bf16 v[148:151], a[116:119], a[64:67], 0
    buffer_load_dwordx4 v[244:247], v126, s[20:23], s57 offen sc1
    v_mfma_f32_16x16x32_bf16 v[152:155], a[120:123], a[64:67], 0
    v_mfma_f32_16x16x32_bf16 v[156:159], a[124:127], a[64:67], 0
    v_mfma_f32_16x16x32_bf16 v[160:163], a[128:131], a[64:67], 0
    v_mfma_f32_16x16x32_bf16 v[164:167], a[132:135], a[64:67], 0
    s_waitcnt vmcnt(12)
    v_mfma_f32_16x16x32_bf16 v[128:131], a[136:139], a[76:79], v[128:131]
    v_mfma_f32_16x16x32_bf16 v[132:135], a[140:143], a[76:79], v[132:135]
    buffer_load_dwordx4 v[248:251], v126, s[20:23], s56 offen offset:1024 sc1
    v_mfma_f32_16x16x32_bf16 v[136:139], a[144:147], a[76:79], v[136:139]
    v_mfma_f32_16x16x32_bf16 v[140:143], a[148:151], a[76:79], v[140:143]
    v_mfma_f32_16x16x32_bf16 v[144:147], a[152:155], a[76:79], v[144:147]
    v_mfma_f32_16x16x32_bf16 v[148:151], a[136:139], a[80:83], v[148:151]
    buffer_load_dwordx4 v[252:255], v126, s[20:23], s57 offen offset:1024 sc1
    v_mfma_f32_16x16x32_bf16 v[152:155], a[140:143], a[80:83], v[152:155]
    v_mfma_f32_16x16x32_bf16 v[156:159], a[144:147], a[80:83], v[156:159]
    v_mfma_f32_16x16x32_bf16 v[160:163], a[148:151], a[80:83], v[160:163]
    v_mfma_f32_16x16x32_bf16 v[164:167], a[152:155], a[80:83], v[164:167]
    s_waitcnt vmcnt(12)
    v_mfma_f32_16x16x32_bf16 v[128:131], a[156:159], a[84:87], v[128:131]
    v_mfma_f32_16x16x32_bf16 v[132:135], a[160:163], a[84:87], v[132:135]
    buffer_load_dwordx4 v[24:27], v126, s[20:23], s56 offen offset:2048 sc1
    v_mfma_f32_16x16x32_bf16 v[136:139], a[164:167], a[84:87], v[136:139]
    v_mfma_f32_16x16x32_bf16 v[140:143], a[168:171], a[84:87], v[140:143]
    v_mfma_f32_16x16x32_bf16 v[144:147], a[172:175], a[84:87], v[144:147]
    v_mfma_f32_16x16x32_bf16 v[148:151], a[156:159], a[88:91], v[148:151]
    buffer_load_dwordx4 v[28:31], v126, s[20:23], s57 offen offset:2048 sc1
    v_mfma_f32_16x16x32_bf16 v[152:155], a[160:163], a[88:91], v[152:155]
    v_mfma_f32_16x16x32_bf16 v[156:159], a[164:167], a[88:91], v[156:159]
    v_mfma_f32_16x16x32_bf16 v[160:163], a[168:171], a[88:91], v[160:163]
    v_mfma_f32_16x16x32_bf16 v[164:167], a[172:175], a[88:91], v[164:167]
    s_waitcnt vmcnt(12)
    v_mfma_f32_16x16x32_bf16 v[128:131], a[176:179], v[208:211], v[128:131]
    v_mfma_f32_16x16x32_bf16 v[132:135], a[180:183], v[208:211], v[132:135]
    buffer_load_dwordx4 v[32:35], v126, s[20:23], s56 offen offset:3072 sc1
    v_mfma_f32_16x16x32_bf16 v[136:139], a[184:187], v[208:211], v[136:139]
    v_mfma_f32_16x16x32_bf16 v[140:143], a[188:191], v[208:211], v[140:143]
    v_mfma_f32_16x16x32_bf16 v[144:147], a[192:195], v[208:211], v[144:147]
    v_mfma_f32_16x16x32_bf16 v[148:151], a[176:179], v[212:215], v[148:151]
    buffer_load_dwordx4 v[36:39], v126, s[20:23], s57 offen offset:3072 sc1
    v_mfma_f32_16x16x32_bf16 v[152:155], a[180:183], v[212:215], v[152:155]
    v_mfma_f32_16x16x32_bf16 v[156:159], a[184:187], v[212:215], v[156:159]
    v_mfma_f32_16x16x32_bf16 v[160:163], a[188:191], v[212:215], v[160:163]
    v_mfma_f32_16x16x32_bf16 v[164:167], a[192:195], v[212:215], v[164:167]
    s_waitcnt vmcnt(12)
    v_mfma_f32_16x16x32_bf16 v[128:131], a[196:199], v[216:219], v[128:131]
    v_mfma_f32_16x16x32_bf16 v[132:135], a[200:203], v[216:219], v[132:135]
    buffer_load_dwordx4 v[40:43], v127, s[20:23], s56 offen sc1
    v_mfma_f32_16x16x32_bf16 v[136:139], a[204:207], v[216:219], v[136:139]
    v_mfma_f32_16x16x32_bf16 v[140:143], a[208:211], v[216:219], v[140:143]
    v_mfma_f32_16x16x32_bf16 v[144:147], a[212:215], v[216:219], v[144:147]
    v_mfma_f32_16x16x32_bf16 v[148:151], a[196:199], v[220:223], v[148:151]
    buffer_load_dwordx4 v[44:47], v127, s[20:23], s57 offen sc1
    v_mfma_f32_16x16x32_bf16 v[152:155], a[200:203], v[220:223], v[152:155]
    v_mfma_f32_16x16x32_bf16 v[156:159], a[204:207], v[220:223], v[156:159]
    v_mfma_f32_16x16x32_bf16 v[160:163], a[208:211], v[220:223], v[160:163]
    v_mfma_f32_16x16x32_bf16 v[164:167], a[212:215], v[220:223], v[164:167]
    s_waitcnt vmcnt(12)
    v_mfma_f32_16x16x32_bf16 v[128:131], a[216:219], v[224:227], v[128:131]
    v_mfma_f32_16x16x32_bf16 v[132:135], a[220:223], v[224:227], v[132:135]
    buffer_load_dwordx4 v[48:51], v127, s[20:23], s56 offen offset:1024 sc1
    v_mfma_f32_16x16x32_bf16 v[136:139], a[224:227], v[224:227], v[136:139]
    v_mfma_f32_16x16x32_bf16 v[140:143], a[228:231], v[224:227], v[140:143]
    v_mfma_f32_16x16x32_bf16 v[144:147], a[232:235], v[224:227], v[144:147]
    v_mfma_f32_16x16x32_bf16 v[148:151], a[216:219], v[228:231], v[148:151]
    buffer_load_dwordx4 v[52:55], v127, s[20:23], s57 offen offset:1024 sc1
    v_mfma_f32_16x16x32_bf16 v[152:155], a[220:223], v[228:231], v[152:155]
    v_mfma_f32_16x16x32_bf16 v[156:159], a[224:227], v[228:231], v[156:159]
    v_mfma_f32_16x16x32_bf16 v[160:163], a[228:231], v[228:231], v[160:163]
    v_mfma_f32_16x16x32_bf16 v[164:167], a[232:235], v[228:231], v[164:167]
    s_waitcnt vmcnt(12)
    v_mfma_f32_16x16x32_bf16 v[128:131], a[236:239], v[232:235], v[128:131]
    v_mfma_f32_16x16x32_bf16 v[132:135], a[240:243], v[232:235], v[132:135]
    v_mfma_f32_16x16x32_bf16 v[136:139], a[244:247], v[232:235], v[136:139]
    v_mfma_f32_16x16x32_bf16 v[140:143], a[248:251], v[232:235], v[140:143]
    v_mfma_f32_16x16x32_bf16 v[144:147], a[252:255], v[232:235], v[144:147]
    v_mfma_f32_16x16x32_bf16 v[148:151], a[236:239], v[236:239], v[148:151]
    v_mfma_f32_16x16x32_bf16 v[152:155], a[240:243], v[236:239], v[152:155]
    v_mfma_f32_16x16x32_bf16 v[156:159], a[244:247], v[236:239], v[156:159]
    v_mfma_f32_16x16x32_bf16 v[160:163], a[248:251], v[236:239], v[160:163]
    v_mfma_f32_16x16x32_bf16 v[164:167], a[252:255], v[236:239], v[164:167]
    s_waitcnt vmcnt(10)
    v_mfma_f32_16x16x32_bf16 v[128:131], v[64:67], v[240:243], v[128:131]
    v_mfma_f32_16x16x32_bf16 v[132:135], v[68:71], v[240:243], v[132:135]
    buffer_load_dword v124, v23, s[20:23], s64 offen offset:128 sc1
    v_mfma_f32_16x16x32_bf16 v[136:139], v[72:75], v[240:243], v[136:139]
    v_mfma_f32_16x16x32_bf16 v[140:143], v[76:79], v[240:243], v[140:143]
    v_mfma_f32_16x16x32_bf16 v[144:147], v[80:83], v[240:243], v[144:147]
    v_mfma_f32_16x16x32_bf16 v[148:151], v[64:67], v[244:247], v[148:151]
    v_mfma_f32_16x16x32_bf16 v[152:155], v[68:71], v[244:247], v[152:155]
    v_mfma_f32_16x16x32_bf16 v[156:159], v[72:75], v[244:247], v[156:159]
    v_mfma_f32_16x16x32_bf16 v[160:163], v[76:79], v[244:247], v[160:163]
    v_mfma_f32_16x16x32_bf16 v[164:167], v[80:83], v[244:247], v[164:167]
    s_waitcnt vmcnt(9)
    v_mfma_f32_16x16x32_bf16 v[128:131], v[84:87], v[248:251], v[128:131]
    v_mfma_f32_16x16x32_bf16 v[132:135], v[88:91], v[248:251], v[132:135]
    v_mfma_f32_16x16x32_bf16 v[136:139], v[92:95], v[248:251], v[136:139]
    v_mfma_f32_16x16x32_bf16 v[140:143], v[96:99], v[248:251], v[140:143]
    v_mfma_f32_16x16x32_bf16 v[144:147], v[100:103], v[248:251], v[144:147]
    v_mfma_f32_16x16x32_bf16 v[148:151], v[84:87], v[252:255], v[148:151]
    v_mfma_f32_16x16x32_bf16 v[152:155], v[88:91], v[252:255], v[152:155]
    v_mfma_f32_16x16x32_bf16 v[156:159], v[92:95], v[252:255], v[156:159]
    v_mfma_f32_16x16x32_bf16 v[160:163], v[96:99], v[252:255], v[160:163]
    v_mfma_f32_16x16x32_bf16 v[164:167], v[100:103], v[252:255], v[164:167]
    s_waitcnt vmcnt(7)
    v_mfma_f32_16x16x32_bf16 v[128:131], v[104:107], v[24:27], v[128:131]
    v_mfma_f32_16x16x32_bf16 v[132:135], v[108:111], v[24:27], v[132:135]
    v_mfma_f32_16x16x32_bf16 v[136:139], v[112:115], v[24:27], v[136:139]
    v_mfma_f32_16x16x32_bf16 v[140:143], v[116:119], v[24:27], v[140:143]
    v_mfma_f32_16x16x32_bf16 v[144:147], v[120:123], v[24:27], v[144:147]
    v_mfma_f32_16x16x32_bf16 v[148:151], v[104:107], v[28:31], v[148:151]
    v_mfma_f32_16x16x32_bf16 v[152:155], v[108:111], v[28:31], v[152:155]
    v_mfma_f32_16x16x32_bf16 v[156:159], v[112:115], v[28:31], v[156:159]
    v_mfma_f32_16x16x32_bf16 v[160:163], v[116:119], v[28:31], v[160:163]
    v_mfma_f32_16x16x32_bf16 v[164:167], v[120:123], v[28:31], v[164:167]
    s_waitcnt vmcnt(0)
    v_cmp_ne_u32 vcc, s45, v124
    s_nop 1
    s_cmp_eq_u64 vcc, 0
    s_cbranch_scc1 standalone__swiglu_ffn__prompt_kernel_polledLB
    s_mov_b32 s63, 0
standalone__swiglu_ffn__prompt_kernel_spinLB:
    buffer_load_dword v124, v23, s[20:23], s64 offen offset:128 sc1
    s_add_u32 s63, s63, 1
    s_waitcnt vmcnt(0)
    v_cmp_ne_u32 vcc, s45, v124
    s_cmp_ge_u32 s63, 60000
    s_cbranch_scc1 standalone__swiglu_ffn__prompt_kernel_polledLB
    s_cmp_eq_u64 vcc, 0
    s_cbranch_scc1 standalone__swiglu_ffn__prompt_kernel_polledLB
    s_sleep 1
    s_branch standalone__swiglu_ffn__prompt_kernel_spinLB
standalone__swiglu_ffn__prompt_kernel_polledLB:
    s_waitcnt vmcnt(5)
    v_mfma_f32_16x16x32_bf16 v[128:131], a[0:3], v[32:35], v[128:131]
    v_mfma_f32_16x16x32_bf16 v[132:135], a[4:7], v[32:35], v[132:135]
    buffer_load_dwordx4 a[60:63], v22, s[20:23], s58 offen offset:1024 sc1
    v_mfma_f32_16x16x32_bf16 v[136:139], a[8:11], v[32:35], v[136:139]
    v_mfma_f32_16x16x32_bf16 v[140:143], a[12:15], v[32:35], v[140:143]
    buffer_load_dwordx4 a[64:67], v22, s[20:23], s59 offen offset:1024 sc1
    v_mfma_f32_16x16x32_bf16 v[144:147], a[16:19], v[32:35], v[144:147]
    v_mfma_f32_16x16x32_bf16 v[148:151], a[0:3], v[36:39], v[148:151]
    buffer_load_dwordx4 a[76:79], v22, s[20:23], s58 offen offset:2048 sc1
    v_mfma_f32_16x16x32_bf16 v[152:155], a[4:7], v[36:39], v[152:155]
    v_mfma_f32_16x16x32_bf16 v[156:159], a[8:11], v[36:39], v[156:159]
    buffer_load_dwordx4 a[80:83], v22, s[20:23], s59 offen offset:2048 sc1
    v_mfma_f32_16x16x32_bf16 v[160:163], a[12:15], v[36:39], v[160:163]
    v_mfma_f32_16x16x32_bf16 v[164:167], a[16:19], v[36:39], v[164:167]
    s_waitcnt vmcnt(7)
    v_mfma_f32_16x16x32_bf16 v[128:131], a[20:23], v[40:43], v[128:131]
    v_mfma_f32_16x16x32_bf16 v[132:135], a[24:27], v[40:43], v[132:135]
    buffer_load_dwordx4 a[84:87], v22, s[20:23], s58 offen offset:3072 sc1
    v_mfma_f32_16x16x32_bf16 v[136:139], a[28:31], v[40:43], v[136:139]
    v_mfma_f32_16x16x32_bf16 v[140:143], a[32:35], v[40:43], v[140:143]
    v_mfma_f32_16x16x32_bf16 v[144:147], a[36:39], v[40:43], v[144:147]
    v_mfma_f32_16x16x32_bf16 v[148:151], a[20:23], v[44:47], v[148:151]
    buffer_load_dwordx4 a[88:91], v22, s[20:23], s59 offen offset:3072 sc1
    v_mfma_f32_16x16x32_bf16 v[152:155], a[24:27], v[44:47], v[152:155]
    v_mfma_f32_16x16x32_bf16 v[156:159], a[28:31], v[44:47], v[156:159]
    v_mfma_f32_16x16x32_bf16 v[160:163], a[32:35], v[44:47], v[160:163]
    v_mfma_f32_16x16x32_bf16 v[164:167], a[36:39], v[44:47], v[164:167]
    s_waitcnt vmcnt(7)
    v_mfma_f32_16x16x32_bf16 v[128:131], a[40:43], v[48:51], v[128:131]
    v_mfma_f32_16x16x32_bf16 v[132:135], a[44:47], v[48:51], v[132:135]
    buffer_load_dwordx4 v[208:211], v125, s[20:23], s58 offen sc1
    v_mfma_f32_16x16x32_bf16 v[136:139], a[48:51], v[48:51], v[136:139]
    v_mfma_f32_16x16x32_bf16 v[140:143], a[52:55], v[48:51], v[140:143]
    v_mfma_f32_16x16x32_bf16 v[144:147], a[56:59], v[48:51], v[144:147]
    v_mfma_f32_16x16x32_bf16 v[148:151], a[40:43], v[52:55], v[148:151]
    buffer_load_dwordx4 v[212:215], v125, s[20:23], s59 offen sc1
    v_mfma_f32_16x16x32_bf16 v[152:155], a[44:47], v[52:55], v[152:155]
    v_mfma_f32_16x16x32_bf16 v[156:159], a[48:51], v[52:55], v[156:159]
    v_mfma_f32_16x16x32_bf16 v[160:163], a[52:55], v[52:55], v[160:163]
    v_mfma_f32_16x16x32_bf16 v[164:167], a[56:59], v[52:55], v[164:167]
    s_waitcnt vmcnt(6)
    v_mfma_f32_16x16x32_bf16 v[168:171], a[116:119], a[60:63], 0
    v_mfma_f32_16x16x32_bf16 v[172:175], a[120:123], a[60:63], 0
    buffer_load_dwordx4 v[216:219], v125, s[20:23], s58 offen offset:1024 sc1
    v_mfma_f32_16x16x32_bf16 v[176:179], a[124:127], a[60:63], 0
    v_mfma_f32_16x16x32_bf16 v[180:183], a[128:131], a[60:63], 0
    buffer_load_dwordx4 v[220:223], v125, s[20:23], s59 offen offset:1024 sc1
    v_mfma_f32_16x16x32_bf16 v[184:187], a[132:135], a[60:63], 0
    ds_write_b128 v6, v[128:131] offset:0
    v_mfma_f32_16x16x32_bf16 v[188:191], a[116:119], a[64:67], 0
    ds_write_b128 v6, v[132:135] offset:1024
    v_mfma_f32_16x16x32_bf16 v[192:195], a[120:123], a[64:67], 0
    ds_write_b128 v6, v[136:139] offset:2048
    buffer_load_dwordx4 v[224:227], v125, s[20:23], s58 offen offset:2048 sc1
    v_mfma_f32_16x16x32_bf16 v[196:199], a[124:127], a[64:67], 0
    ds_write_b128 v6, v[140:143] offset:3072
    v_mfma_f32_16x16x32_bf16 v[200:203], a[128:131], a[64:67], 0
    ds_write_b128 v6, v[144:147] offset:4096
    v_mfma_f32_16x16x32_bf16 v[204:207], a[132:135], a[64:67], 0
    s_waitcnt vmcnt(7)
    v_mfma_f32_16x16x32_bf16 v[168:171], a[136:139], a[76:79], v[168:171]
    v_mfma_f32_16x16x32_bf16 v[172:175], a[140:143], a[76:79], v[172:175]
    buffer_load_dwordx4 v[228:231], v125, s[20:23], s59 offen offset:2048 sc1
    v_mfma_f32_16x16x32_bf16 v[176:179], a[144:147], a[76:79], v[176:179]
    v_mfma_f32_16x16x32_bf16 v[180:183], a[148:151], a[76:79], v[180:183]
    buffer_load_dwordx4 v[232:235], v125, s[20:23], s58 offen offset:3072 sc1
    v_mfma_f32_16x16x32_bf16 v[184:187], a[152:155], a[76:79], v[184:187]
    v_mfma_f32_16x16x32_bf16 v[188:191], a[136:139], a[80:83], v[188:191]
    v_mfma_f32_16x16x32_bf16 v[192:195], a[140:143], a[80:83], v[192:195]
    buffer_load_dwordx4 v[236:239], v125, s[20:23], s59 offen offset:3072 sc1
    v_mfma_f32_16x16x32_bf16 v[196:199], a[144:147], a[80:83], v[196:199]
    v_mfma_f32_16x16x32_bf16 v[200:203], a[148:151], a[80:83], v[200:203]
    v_mfma_f32_16x16x32_bf16 v[204:207], a[152:155], a[80:83], v[204:207]
    s_waitcnt vmcnt(8)
    v_mfma_f32_16x16x32_bf16 v[168:171], a[156:159], a[84:87], v[168:171]
    v_mfma_f32_16x16x32_bf16 v[172:175], a[160:163], a[84:87], v[172:175]
    buffer_load_dwordx4 v[240:243], v126, s[20:23], s58 offen sc1
    v_mfma_f32_16x16x32_bf16 v[176:179], a[164:167], a[84:87], v[176:179]
    v_mfma_f32_16x16x32_bf16 v[180:183], a[168:171], a[84:87], v[180:183]
    buffer_load_dwordx4 v[244:247], v126, s[20:23], s59 offen sc1
    v_mfma_f32_16x16x32_bf16 v[184:187], a[172:175], a[84:87], v[184:187]
    v_mfma_f32_16x16x32_bf16 v[188:191], a[156:159], a[88:91], v[188:191]
    v_mfma_f32_16x16x32_bf16 v[192:195], a[160:163], a[88:91], v[192:195]
    buffer_load_dwordx4 v[248:251], v126, s[20:23], s58 offen offset:1024 sc1
    v_mfma_f32_16x16x32_bf16 v[196:199], a[164:167], a[88:91], v[196:199]
    v_mfma_f32_16x16x32_bf16 v[200:203], a[168:171], a[88:91], v[200:203]
    v_mfma_f32_16x16x32_bf16 v[204:207], a[172:175], a[88:91], v[204:207]
    s_waitcnt vmcnt(9)
    v_mfma_f32_16x16x32_bf16 v[168:171], a[176:179], v[208:211], v[168:171]
    v_mfma_f32_16x16x32_bf16 v[172:175], a[180:183], v[208:211], v[172:175]
    buffer_load_dwordx4 v[252:255], v126, s[20:23], s59 offen offset:1024 sc1
    v_mfma_f32_16x16x32_bf16 v[176:179], a[184:187], v[208:211], v[176:179]
    v_mfma_f32_16x16x32_bf16 v[180:183], a[188:191], v[208:211], v[180:183]
    buffer_load_dwordx4 v[24:27], v126, s[20:23], s58 offen offset:2048 sc1
    v_mfma_f32_16x16x32_bf16 v[184:187], a[192:195], v[208:211], v[184:187]
    v_mfma_f32_16x16x32_bf16 v[188:191], a[176:179], v[212:215], v[188:191]
    v_mfma_f32_16x16x32_bf16 v[192:195], a[180:183], v[212:215], v[192:195]
    buffer_load_dwordx4 v[28:31], v126, s[20:23], s59 offen offset:2048 sc1
    v_mfma_f32_16x16x32_bf16 v[196:199], a[184:187], v[212:215], v[196:199]
    v_mfma_f32_16x16x32_bf16 v[200:203], a[188:191], v[212:215], v[200:203]
    v_mfma_f32_16x16x32_bf16 v[204:207], a[192:195], v[212:215], v[204:207]
    s_waitcnt vmcnt(10)
    s_waitcnt lgkmcnt(0)
    s_barrier
    v_mfma_f32_16x16x32_bf16 v[168:171], a[196:199], v[216:219], v[168:171]
    v_mfma_f32_16x16x32_bf16 v[172:175], a[200:203], v[216:219], v[172:175]
    buffer_load_dwordx4 v[32:35], v126, s[20:23], s58 offen offset:3072 sc1
    v_mfma_f32_16x16x32_bf16 v[176:179], a[204:207], v[216:219], v[176:179]
    v_mfma_f32_16x16x32_bf16 v[180:183], a[208:211], v[216:219], v[180:183]
    buffer_load_dwordx4 v[36:39], v126, s[20:23], s59 offen offset:3072 sc1
    v_mfma_f32_16x16x32_bf16 v[184:187], a[212:215], v[216:219], v[184:187]
    v_mfma_f32_16x16x32_bf16 v[188:191], a[196:199], v[220:223], v[188:191]
    v_mfma_f32_16x16x32_bf16 v[192:195], a[200:203], v[220:223], v[192:195]
    buffer_load_dwordx4 v[40:43], v127, s[20:23], s58 offen sc1
    v_mfma_f32_16x16x32_bf16 v[196:199], a[204:207], v[220:223], v[196:199]
    v_mfma_f32_16x16x32_bf16 v[200:203], a[208:211], v[220:223], v[200:203]
    v_mfma_f32_16x16x32_bf16 v[204:207], a[212:215], v[220:223], v[204:207]
    s_waitcnt vmcnt(11)
    v_mfma_f32_16x16x32_bf16 v[168:171], a[216:219], v[224:227], v[168:171]
    ds_read_b128 v[56:59], v10 offset:0
    ds_read_b128 v[60:63], v10 offset:5120
    ds_read_b128 v[16:19], v10 offset:10240
    v_mfma_f32_16x16x32_bf16 v[172:175], a[220:223], v[224:227], v[172:175]
    buffer_load_dwordx4 v[44:47], v127, s[20:23], s59 offen sc1
    v_mfma_f32_16x16x32_bf16 v[176:179], a[224:227], v[224:227], v[176:179]
    v_mfma_f32_16x16x32_bf16 v[180:183], a[228:231], v[224:227], v[180:183]
    buffer_load_dwordx4 v[48:51], v127, s[20:23], s58 offen offset:1024 sc1
    v_mfma_f32_16x16x32_bf16 v[184:187], a[232:235], v[224:227], v[184:187]
    s_waitcnt lgkmcnt(0)
    v_add_f32 v148, v148, v56
    v_add_f32 v149, v149, v57
    v_mfma_f32_16x16x32_bf16 v[188:191], a[216:219], v[228:231], v[188:191]
    v_add_f32 v150, v150, v58
    v_add_f32 v151, v151, v59
    v_add_f32 v148, v148, v60
    v_mfma_f32_16x16x32_bf16 v[192:195], a[220:223], v[228:231], v[192:195]
    v_add_f32 v149, v149, v61
    v_add_f32 v150, v150, v62
    buffer_load_dwordx4 v[52:55], v127, s[20:23], s59 offen offset:1024 sc1
    v_mfma_f32_16x16x32_bf16 v[196:199], a[224:227], v[228:231], v[196:199]
    v_add_f32 v151, v151, v63
    v_add_f32 v148, v148, v16
    v_add_f32 v149, v149, v17
    v_mfma_f32_16x16x32_bf16 v[200:203], a[228:231], v[228:231], v[200:203]
    v_add_f32 v150, v150, v18
    v_add_f32 v151, v151, v19
    v_cvt_pk_bf16_f32 v12, v148, v149
    v_mfma_f32_16x16x32_bf16 v[204:207], a[232:235], v[228:231], v[204:207]
    v_cvt_pk_bf16_f32 v13, v150, v151
    buffer_store_dwordx2 v[12:13], v11, s[28:31], s67 offen offset:0
    s_waitcnt vmcnt(13)
    v_mfma_f32_16x16x32_bf16 v[168:171], a[236:239], v[232:235], v[168:171]
    ds_read_b128 v[56:59], v10 offset:1024
    ds_read_b128 v[60:63], v10 offset:6144
    ds_read_b128 v[16:19], v10 offset:11264
    v_mfma_f32_16x16x32_bf16 v[172:175], a[240:243], v[232:235], v[172:175]
    v_mfma_f32_16x16x32_bf16 v[176:179], a[244:247], v[232:235], v[176:179]
    v_mfma_f32_16x16x32_bf16 v[180:183], a[248:251], v[232:235], v[180:183]
    v_mfma_f32_16x16x32_bf16 v[184:187], a[252:255], v[232:235], v[184:187]
    s_waitcnt lgkmcnt(0)
    v_add_f32 v152, v152, v56
    v_add_f32 v153, v153, v57
    v_mfma_f32_16x16x32_bf16 v[188:191], a[236:239], v[236:239], v[188:191]
    v_add_f32 v154, v154, v58
    v_add_f32 v155, v155, v59
    v_add_f32 v152, v152, v60
    v_mfma_f32_16x16x32_bf16 v[192:195], a[240:243], v[236:239], v[192:195]
    v_add_f32 v153, v153, v61
    v_add_f32 v154, v154, v62
    v_mfma_f32_16x16x32_bf16 v[196:199], a[244:247], v[236:239], v[196:199]
    v_add_f32 v155, v155, v63
    v_add_f32 v152, v152, v16
    v_add_f32 v153, v153, v17
    v_mfma_f32_16x16x32_bf16 v[200:203], a[248:251], v[236:239], v[200:203]
    v_add_f32 v154, v154, v18
    v_add_f32 v155, v155, v19
    v_cvt_pk_bf16_f32 v12, v152, v153
    v_mfma_f32_16x16x32_bf16 v[204:207], a[252:255], v[236:239], v[204:207]
    v_cvt_pk_bf16_f32 v13, v154, v155
    buffer_store_dwordx2 v[12:13], v11, s[28:31], s67 offen offset:32
    s_waitcnt vmcnt(12)
    v_mfma_f32_16x16x32_bf16 v[168:171], v[64:67], v[240:243], v[168:171]
    ds_read_b128 v[56:59], v10 offset:2048
    ds_read_b128 v[60:63], v10 offset:7168
    ds_read_b128 v[16:19], v10 offset:12288
    v_mfma_f32_16x16x32_bf16 v[172:175], v[68:71], v[240:243], v[172:175]
    v_mfma_f32_16x16x32_bf16 v[176:179], v[72:75], v[240:243], v[176:179]
    v_mfma_f32_16x16x32_bf16 v[180:183], v[76:79], v[240:243], v[180:183]
    v_mfma_f32_16x16x32_bf16 v[184:187], v[80:83], v[240:243], v[184:187]
    s_waitcnt lgkmcnt(0)
    v_add_f32 v156, v156, v56
    v_add_f32 v157, v157, v57
    v_mfma_f32_16x16x32_bf16 v[188:191], v[64:67], v[244:247], v[188:191]
    v_add_f32 v158, v158, v58
    v_add_f32 v159, v159, v59
    v_add_f32 v156, v156, v60
    v_mfma_f32_16x16x32_bf16 v[192:195], v[68:71], v[244:247], v[192:195]
    v_add_f32 v157, v157, v61
    v_add_f32 v158, v158, v62
    v_mfma_f32_16x16x32_bf16 v[196:199], v[72:75], v[244:247], v[196:199]
    v_add_f32 v159, v159, v63
    v_add_f32 v156, v156, v16
    v_add_f32 v157, v157, v17
    v_mfma_f32_16x16x32_bf16 v[200:203], v[76:79], v[244:247], v[200:203]
    v_add_f32 v158, v158, v18
    v_add_f32 v159, v159, v19
    v_cvt_pk_bf16_f32 v12, v156, v157
    v_mfma_f32_16x16x32_bf16 v[204:207], v[80:83], v[244:247], v[204:207]
    v_cvt_pk_bf16_f32 v13, v158, v159
    buffer_store_dwordx2 v[12:13], v11, s[28:31], s67 offen offset:64
    s_waitcnt vmcnt(11)
    v_mfma_f32_16x16x32_bf16 v[168:171], v[84:87], v[248:251], v[168:171]
    ds_read_b128 v[56:59], v10 offset:3072
    ds_read_b128 v[60:63], v10 offset:8192
    ds_read_b128 v[16:19], v10 offset:13312
    v_mfma_f32_16x16x32_bf16 v[172:175], v[88:91], v[248:251], v[172:175]
    v_mfma_f32_16x16x32_bf16 v[176:179], v[92:95], v[248:251], v[176:179]
    v_mfma_f32_16x16x32_bf16 v[180:183], v[96:99], v[248:251], v[180:183]
    v_mfma_f32_16x16x32_bf16 v[184:187], v[100:103], v[248:251], v[184:187]
    s_waitcnt lgkmcnt(0)
    v_add_f32 v160, v160, v56
    v_add_f32 v161, v161, v57
    v_mfma_f32_16x16x32_bf16 v[188:191], v[84:87], v[252:255], v[188:191]
    v_add_f32 v162, v162, v58
    v_add_f32 v163, v163, v59
    v_add_f32 v160, v160, v60
    v_mfma_f32_16x16x32_bf16 v[192:195], v[88:91], v[252:255], v[192:195]
    v_add_f32 v161, v161, v61
    v_add_f32 v162, v162, v62
    v_mfma_f32_16x16x32_bf16 v[196:199], v[92:95], v[252:255], v[196:199]
    v_add_f32 v163, v163, v63
    v_add_f32 v160, v160, v16
    v_add_f32 v161, v161, v17
    v_mfma_f32_16x16x32_bf16 v[200:203], v[96:99], v[252:255], v[200:203]
    v_add_f32 v162, v162, v18
    v_add_f32 v163, v163, v19
    v_cvt_pk_bf16_f32 v12, v160, v161
    v_mfma_f32_16x16x32_bf16 v[204:207], v[100:103], v[252:255], v[204:207]
    v_cvt_pk_bf16_f32 v13, v162, v163
    buffer_store_dwordx2 v[12:13], v11, s[28:31], s67 offen offset:96
    s_waitcnt vmcnt(10)
    v_mfma_f32_16x16x32_bf16 v[168:171], v[104:107], v[24:27], v[168:171]
    ds_read_b128 v[56:59], v10 offset:4096
    ds_read_b128 v[60:63], v10 offset:9216
    ds_read_b128 v[16:19], v10 offset:14336
    v_mfma_f32_16x16x32_bf16 v[172:175], v[108:111], v[24:27], v[172:175]
    v_mfma_f32_16x16x32_bf16 v[176:179], v[112:115], v[24:27], v[176:179]
    v_mfma_f32_16x16x32_bf16 v[180:183], v[116:119], v[24:27], v[180:183]
    v_mfma_f32_16x16x32_bf16 v[184:187], v[120:123], v[24:27], v[184:187]
    s_waitcnt lgkmcnt(0)
    v_add_f32 v164, v164, v56
    v_add_f32 v165, v165, v57
    v_mfma_f32_16x16x32_bf16 v[188:191], v[104:107], v[28:31], v[188:191]
    v_add_f32 v166, v166, v58
    v_add_f32 v167, v167, v59
    v_add_f32 v164, v164, v60
    v_mfma_f32_16x16x32_bf16 v[192:195], v[108:111], v[28:31], v[192:195]
    v_add_f32 v165, v165, v61
    v_add_f32 v166, v166, v62
    v_mfma_f32_16x16x32_bf16 v[196:199], v[112:115], v[28:31], v[196:199]
    v_add_f32 v167, v167, v63
    v_add_f32 v164, v164, v16
    v_add_f32 v165, v165, v17
    v_mfma_f32_16x16x32_bf16 v[200:203], v[116:119], v[28:31], v[200:203]
    v_add_f32 v166, v166, v18
    v_add_f32 v167, v167, v19
    v_cvt_pk_bf16_f32 v12, v164, v165
    v_mfma_f32_16x16x32_bf16 v[204:207], v[120:123], v[28:31], v[204:207]
    v_cvt_pk_bf16_f32 v13, v166, v167
    buffer_store_dwordx2 v[12:13], v11, s[28:31], s67 offen offset:128
    s_waitcnt vmcnt(5)
    v_mfma_f32_16x16x32_bf16 v[168:171], a[0:3], v[32:35], v[168:171]
    v_mfma_f32_16x16x32_bf16 v[172:175], a[4:7], v[32:35], v[172:175]
    v_mfma_f32_16x16x32_bf16 v[176:179], a[8:11], v[32:35], v[176:179]
    v_mfma_f32_16x16x32_bf16 v[180:183], a[12:15], v[32:35], v[180:183]
    v_mfma_f32_16x16x32_bf16 v[184:187], a[16:19], v[32:35], v[184:187]
    v_mfma_f32_16x16x32_bf16 v[168:171], a[20:23], v[40:43], v[168:171]
    v_mfma_f32_16x16x32_bf16 v[172:175], a[24:27], v[40:43], v[172:175]
    v_mfma_f32_16x16x32_bf16 v[176:179], a[28:31], v[40:43], v[176:179]
    v_mfma_f32_16x16x32_bf16 v[180:183], a[32:35], v[40:43], v[180:183]
    v_mfma_f32_16x16x32_bf16 v[184:187], a[36:39], v[40:43], v[184:187]
    v_mfma_f32_16x16x32_bf16 v[168:171], a[40:43], v[48:51], v[168:171]
    v_mfma_f32_16x16x32_bf16 v[172:175], a[44:47], v[48:51], v[172:175]
    v_mfma_f32_16x16x32_bf16 v[176:179], a[48:51], v[48:51], v[176:179]
    v_mfma_f32_16x16x32_bf16 v[180:183], a[52:55], v[48:51], v[180:183]
    v_mfma_f32_16x16x32_bf16 v[184:187], a[56:59], v[48:51], v[184:187]
    v_mfma_f32_16x16x32_bf16 v[188:191], a[0:3], v[36:39], v[188:191]
    v_mfma_f32_16x16x32_bf16 v[192:195], a[4:7], v[36:39], v[192:195]
    v_mfma_f32_16x16x32_bf16 v[196:199], a[8:11], v[36:39], v[196:199]
    v_mfma_f32_16x16x32_bf16 v[200:203], a[12:15], v[36:39], v[200:203]
    v_mfma_f32_16x16x32_bf16 v[204:207], a[16:19], v[36:39], v[204:207]
    v_mfma_f32_16x16x32_bf16 v[188:191], a[20:23], v[44:47], v[188:191]
    ds_write_b128 v8, v[168:171] offset:0
    v_mfma_f32_16x16x32_bf16 v[192:195], a[24:27], v[44:47], v[192:195]
    v_mfma_f32_16x16x32_bf16 v[196:199], a[28:31], v[44:47], v[196:199]
    ds_write_b128 v8, v[172:175] offset:1024
    v_mfma_f32_16x16x32_bf16 v[200:203], a[32:35], v[44:47], v[200:203]
    v_mfma_f32_16x16x32_bf16 v[204:207], a[36:39], v[44:47], v[204:207]
    ds_write_b128 v8, v[176:179] offset:2048
    v_mfma_f32_16x16x32_bf16 v[188:191], a[40:43], v[52:55], v[188:191]
    v_mfma_f32_16x16x32_bf16 v[192:195], a[44:47], v[52:55], v[192:195]
    ds_write_b128 v8, v[180:183] offset:3072
    v_mfma_f32_16x16x32_bf16 v[196:199], a[48:51], v[52:55], v[196:199]
    v_mfma_f32_16x16x32_bf16 v[200:203], a[52:55], v[52:55], v[200:203]
    ds_write_b128 v8, v[184:187] offset:4096
    v_mfma_f32_16x16x32_bf16 v[204:207], a[56:59], v[52:55], v[204:207]
    s_nop 7
    ds_write_b128 v9, v[188:191] offset:0
    ds_write_b128 v9, v[192:195] offset:1024
    ds_write_b128 v9, v[196:199] offset:2048
    ds_write_b128 v9, v[200:203] offset:3072
    ds_write_b128 v9, v[204:207] offset:4096
    s_waitcnt lgkmcnt(0)
    s_barrier
standalone__swiglu_ffn__prompt_kernel_fin:
standalone__swiglu_ffn__prompt_kernel_end:
    s_endpgm
standalone__swiglu_ffn__prompt_kernel_codeend:
.section .rodata,"a"
.p2align 6
.amdhsa_kernel standalone__swiglu_ffn__prompt_kernel
  .amdhsa_next_free_vgpr 512
  .amdhsa_next_free_sgpr 102
  .amdhsa_accum_offset 256
  .amdhsa_group_segment_fixed_size 0
  .amdhsa_kernarg_size 56
  .amdhsa_user_sgpr_count 2
  .amdhsa_user_sgpr_kernarg_segment_ptr 1
  .amdhsa_system_sgpr_workgroup_id_x 1
.end_amdhsa_kernel
```
